```python
import torch

def _softmax(x, axis=-1):
    return torch.softmax(x, dim=axis)
def _gelu(x):
    return torch.nn.functional.gelu(x, approximate="tanh")
def _silu(x):
    return torch.nn.functional.silu(x)
def _sigmoid(x):
    return torch.sigmoid(x)
def _layernorm(x, axis=-1, eps=1e-5):
    m = x.mean(dim=axis, keepdim=True)
    v = x.var(dim=axis, keepdim=True, unbiased=False)
    return (x - m) / torch.sqrt(v + eps)
def _scatter_add(tgt, idx, src, axis=0):
    return tgt.clone().index_add_(axis, idx, src)
def _segment_sum(src, seg, n):
    out = torch.zeros((n,) + src.shape[1:], dtype=src.dtype)
    return out.index_add_(0, seg, src)
def _pad(x, pw):
    flat = tuple(v for pair in reversed(pw) for v in pair)
    return torch.nn.functional.pad(x, flat)

kernel_name = 'concat_heads__gqa_block_cached__mha_block_cached__near_ridge'

def setup_inputs():

    _w = (lambda a: (lambda t: t.to(torch.bfloat16) if t.is_floating_point() else t)(torch.as_tensor(a)))
    def _A_setup():
        B, Sq, D = 16, 32, 640
        Hq, Hkv, Sk, Dh = 32, 32, 32, 192
        assert Hq % Hkv == 0, (Hq, Hkv)
        return {
            "x": _w((lambda *s: torch.randn(*s, dtype=torch.bfloat16) * 0.8)(B, Sq, D)),
            "k_cache": _w((lambda *s: torch.randn(*s, dtype=torch.bfloat16) * 0.8)(B, Hkv, Sk, Dh)),
            "v_cache": _w((lambda *s: torch.randn(*s, dtype=torch.bfloat16) * 0.05)(B, Hkv, Sk, Dh)),
            "wq": _w((lambda *s: torch.randn(*s, dtype=torch.bfloat16) * 0.8)(D, Hq * Dh) * (D ** -0.5)),
            "wo": _w((lambda *s: torch.randn(*s, dtype=torch.bfloat16) * 0.05)(Hq * Dh, D) * ((Hq * Dh) ** -0.5)),
        }
    _A_in = _A_setup()

    def _B_setup():
        B, Sq, D = 16, 32, 640
        H, Sk, Dh = 32, 32, 192
        return {
            "x": _w((lambda *s: torch.randn(*s, dtype=torch.bfloat16) * 0.8)(B, Sq, D)),
            "k_cache": _w((lambda *s: torch.randn(*s, dtype=torch.bfloat16) * 0.8)(B, H, Sk, Dh)),
            "v_cache": _w((lambda *s: torch.randn(*s, dtype=torch.bfloat16) * 0.05)(B, H, Sk, Dh)),
            "wq": _w((lambda *s: torch.randn(*s, dtype=torch.bfloat16) * 0.8)(D, H * Dh) * (D ** -0.5)),
            "wo": _w((lambda *s: torch.randn(*s, dtype=torch.bfloat16) * 0.05)(H * Dh, D) * ((H * Dh) ** -0.5)),
        }
    _B_in = _B_setup()

    return {
        "A_x": _A_in["x"],
        "A_k_cache": _A_in["k_cache"],
        "A_v_cache": _A_in["v_cache"],
        "A_wq": _A_in["wq"],
        "A_wo": _A_in["wo"],
        "B_x": _B_in["x"],
        "B_k_cache": _B_in["k_cache"],
        "B_v_cache": _B_in["v_cache"],
        "B_wq": _B_in["wq"],
        "B_wo": _B_in["wo"],
    }

def reference(A_x, A_k_cache, A_v_cache, A_wq, A_wo, B_x, B_k_cache, B_v_cache, B_wq, B_wo):
    def _A_ref(x, k_cache, v_cache, wq, wo):
        B, Sq, D = x.shape
        Hq, Dh = 32, 192
        Hkv = k_cache.shape[1]
        rep = Hq // Hkv
        q = (lambda x, *d: x.permute(*d))((x @ wq).reshape(B, Sq, Hq, Dh), 0, 2, 1, 3)
        k = (lambda x, n, axis: torch.repeat_interleave(x, n, dim=axis))(k_cache, rep, axis=1)
        v = (lambda x, n, axis: torch.repeat_interleave(x, n, dim=axis))(v_cache, rep, axis=1)
        scores = torch.einsum("bhqd,bhkd->bhqk", q, k) * (Dh ** -0.5)
        p = _softmax(scores, axis=-1)
        o = torch.einsum("bhqk,bhkd->bhqd", p, v)
        return (lambda x, *d: x.permute(*d))(o, 0, 2, 1, 3).reshape(B, Sq, Hq * Dh) @ wo

    def _B_ref(x, k_cache, v_cache, wq, wo):
        B, Sq, D = x.shape
        H, Dh = 32, 192
        q = (lambda x, *d: x.permute(*d))((x @ wq).reshape(B, Sq, H, Dh), 0, 2, 1, 3)
        scores = torch.einsum("bhqd,bhkd->bhqk", q, k_cache) * (Dh ** -0.5)
        p = _softmax(scores, axis=-1)
        o = torch.einsum("bhqk,bhkd->bhqd", p, v_cache)
        return (lambda x, *d: x.permute(*d))(o, 0, 2, 1, 3).reshape(B, Sq, H * Dh) @ wo

    a = _A_ref(A_x, A_k_cache, A_v_cache, A_wq, A_wo)
    b = _B_ref(B_x, B_k_cache, B_v_cache, B_wq, B_wo)
    return torch.concatenate([a, b], axis=-1)
```

```asm
; @launch grid=(256,1,1) block=(512,1,1) lds=163840
.amdgcn_target "amdgcn-amd-amdhsa--gfx950"
.text
.globl concat_heads__gqa_block_cached__mha_block_cached__near_ridge_kernel
.p2align 8
.type concat_heads__gqa_block_cached__mha_block_cached__near_ridge_kernel,@function
concat_heads__gqa_block_cached__mha_block_cached__near_ridge_kernel:
    s_cmp_ge_u32 s2, 256
    s_cbranch_scc1 kend
    s_and_b32 s40, s2, 7
    s_lshr_b32 s41, s2, 3
    s_lshr_b32 s4, s40, 2
    s_and_b32 s5, s40, 3
    s_and_b32 s6, s41, 3
    s_lshr_b32 s7, s41, 2
    s_mul_i32 s47, s4, 40
    s_add_u32 s44, s0, s47
    s_addc_u32 s45, s1, 0
    s_load_dwordx2 s[8:9], s[44:45], 0
    s_load_dwordx2 s[12:13], s[44:45], 24
    s_load_dwordx2 s[16:17], s[44:45], 8
    s_load_dwordx2 s[20:21], s[44:45], 16
    s_load_dwordx2 s[24:25], s[44:45], 32
    s_load_dwordx2 s[32:33], s[0:1], 80
    s_load_dwordx2 s[36:37], s[0:1], 88
    s_load_dwordx2 s[28:29], s[0:1], 96
    v_lshrrev_b32 v1, 6, v0
    v_and_b32 v0, 63, v0
    s_mov_b32 s10, 0xa0000
    s_mov_b32 s11, 0x20000
    s_mov_b32 s14, 0x780000
    s_mov_b32 s15, 0x20000
    s_mov_b32 s18, 0x600000
    s_mov_b32 s19, 0x20000
    s_mov_b32 s22, 0x600000
    s_mov_b32 s23, 0x20000
    s_mov_b32 s26, 0x780000
    s_mov_b32 s27, 0x20000
    s_mov_b32 s30, 0x2000000
    s_mov_b32 s31, 0x20000
    s_mov_b32 s34, 0x140000
    s_mov_b32 s35, 0x20000
    s_mov_b32 s38, 0x100
    s_mov_b32 s39, 0x20000
    v_readfirstlane_b32 s3, v1
    s_lshl_b32 s46, s5, 3
    s_add_u32 s46, s46, s7
    s_and_b32 s42, s7, 3
    s_lshr_b32 s43, s7, 2
    s_cmp_ge_u32 s3, 4
    s_cbranch_scc0 computew
    s_mov_b32 s63, 0
    s_sub_u32 s58, s3, 4
    v_lshlrev_b32 v14, 4, v0
    v_mov_b32 v22, 0x25000
    s_cmp_lg_u32 s58, 3
    s_cbranch_scc1 init_1
    v_lshlrev_b32 v32, 2, v0
    v_and_b32 v32, 63, v32
    v_add_u32 v32, v32, v22
    v_mov_b32 v33, 0
    ds_write_b32 v32, v33
init_1:
    v_lshrrev_b32 v32, 5, v0
    v_mul_u32_u24 v32, 1280, v32
    v_and_b32 v33, 31, v0
    v_lshl_add_u32 v15, v33, 4, v32
    v_lshrrev_b32 v32, 3, v0
    v_and_b32 v33, 7, v0
    v_lshrrev_b32 v34, 4, v0
    v_xor_b32 v33, v33, v34
    v_mul_u32_u24 v35, 1280, v32
    v_lshl_add_u32 v2, v33, 4, v35
    v_xor_b32 v3, 64, v2
    v_mul_u32_u24 v35, 384, v32
    v_lshl_add_u32 v8, v33, 4, v35
    v_xor_b32 v9, 64, v8
    v_add_u32 v32, 0, v0
    v_mul_u32_u24 v33, 0xaab, v32
    v_lshrrev_b32 v33, 16, v33
    v_mul_u32_u24 v34, 24, v33
    v_sub_u32 v34, v32, v34
    v_bfe_u32 v35, v33, 1, 1
    v_lshlrev_b32 v35, 2, v35
    v_xor_b32 v35, v35, v34
    v_lshlrev_b32 v35, 4, v35
    v_mul_u32_u24 v4, 0x3000, v33
    v_add_u32 v4, v4, v35
    v_add_u32 v32, 64, v0
    v_mul_u32_u24 v33, 0xaab, v32
    v_lshrrev_b32 v33, 16, v33
    v_mul_u32_u24 v34, 24, v33
    v_sub_u32 v34, v32, v34
    v_bfe_u32 v35, v33, 1, 1
    v_lshlrev_b32 v35, 2, v35
    v_xor_b32 v35, v35, v34
    v_lshlrev_b32 v35, 4, v35
    v_mul_u32_u24 v5, 0x3000, v33
    v_add_u32 v5, v5, v35
    v_add_u32 v32, 128, v0
    v_mul_u32_u24 v33, 0xaab, v32
    v_lshrrev_b32 v33, 16, v33
    v_mul_u32_u24 v34, 24, v33
    v_sub_u32 v34, v32, v34
    v_bfe_u32 v35, v33, 1, 1
    v_lshlrev_b32 v35, 2, v35
    v_xor_b32 v35, v35, v34
    v_lshlrev_b32 v35, 4, v35
    v_mul_u32_u24 v6, 0x3000, v33
    v_add_u32 v6, v6, v35
    s_lshl_b32 s52, s6, 7
    s_lshl_b32 s56, s58, 5
    s_add_u32 s52, s52, s56
    s_mul_i32 s52, s52, 1280
    s_mul_i32 s53, s46, 384
    s_mul_i32 s56, s58, 98304
    s_add_u32 s53, s53, s56
    s_lshl_b32 s65, s58, 12
    s_add_u32 s65, s65, 0
    s_mul_i32 s66, s58, 3072
    s_add_u32 s66, s66, 65536
    s_mul_i32 s101, s58, 3
    s_cmp_eq_u32 s58, 3
    s_cselect_b32 s101, 8, s101
    s_lshl_b32 s67, s101, 10
    s_add_u32 s67, s67, 65536
    s_lshl_b32 s56, s58, 2
    s_add_u32 s57, s56, 0x25000
    v_mov_b32 v45, 0
    s_getpc_b64 s[84:85]
pc_here:
    s_add_u32 s84, s84, seqtab-pc_here
    s_addc_u32 s85, s85, 0
    s_mov_b32 s86, 512
    s_mov_b32 s87, 0x20000
    s_mov_b32 s62, 0
    s_mov_b32 s77, 0
    s_mov_b32 s78, 0
    s_mov_b32 s83, 0
    s_mov_b32 s94, 0
    s_lshl_b32 s76, s6, 7
    s_lshl_b32 s56, s7, 4
    s_add_u32 s76, s76, s56
    s_mul_i32 s76, s76, 1280
    s_mul_i32 s56, s58, 5120
    s_add_u32 s76, s76, s56
    s_lshl_b32 s68, s41, 1
    s_lshr_b32 s56, s58, 1
    s_lshl_b32 s56, s56, 6
    s_add_u32 s68, s68, s56
    s_and_b32 s56, s58, 1
    s_add_u32 s68, s68, s56
    s_add_u32 s68, s68, 128
    s_mul_i32 s68, s68, 12288
    s_mul_i32 s56, s5, 3072
    s_add_u32 s68, s68, s56
    s_mov_b32 s88, 0
    s_waitcnt lgkmcnt(0)
    s_barrier
    s_sub_i32 s56, s77, 4
    s_lshl_b32 s82, s56, 1
    s_add_i32 s82, s82, 2
    s_add_i32 s89, s56, 11
    s_cmp_ge_i32 s56, 10
    s_cselect_b32 s82, s89, s82
    s_lshl_b32 s89, s56, 1
    s_sub_i32 s89, s89, 1
    s_cmp_ge_i32 s56, 13
    s_cselect_b32 s82, s89, s82
    s_cmp_ge_i32 s88, s82
    s_cbranch_scc1 gate_2_ok
gate_2:
    ds_read_b128 v[36:39], v22 offset:16
    s_waitcnt lgkmcnt(0)
    v_min3_u32 v36, v36, v37, v38
    v_min_u32 v36, v36, v39
    s_nop 0
    v_readfirstlane_b32 s88, v36
    s_add_u32 s63, s63, 1
    s_cmp_ge_i32 s88, s82
    s_cbranch_scc1 gate_2_ok
    s_cmp_gt_u32 s63, 300000
    s_cbranch_scc0 gate_2
gate_2_ok:
    s_waitcnt vmcnt(24)
    s_lshl_b32 s79, s94, 14
    s_add_u32 s79, s79, s65
    s_add_u32 s94, s94, 1
    s_cmp_eq_u32 s94, 4
    s_cselect_b32 s94, 0, s94
    s_add_u32 m0, s79, 0x0
    s_add_u32 s56, s52, 0x0
    buffer_load_dwordx4 v2, s[8:11], s56 offen lds
    s_add_u32 m0, s79, 0x400
    s_add_u32 s56, s52, 0x2800
    buffer_load_dwordx4 v3, s[8:11], s56 offen lds
    s_add_u32 m0, s79, 0x800
    s_add_u32 s56, s52, 0x5000
    buffer_load_dwordx4 v2, s[8:11], s56 offen lds
    s_add_u32 m0, s79, 0xc00
    s_add_u32 s56, s52, 0x7800
    buffer_load_dwordx4 v3, s[8:11], s56 offen lds
    s_add_u32 s62, s62, 1
    s_add_u32 s77, s77, 1
    s_add_u32 s52, s52, 128
    s_sub_i32 s82, s78, 6
    s_add_i32 s56, s82, 3
    s_cmp_ge_i32 s78, 27
    s_cselect_b32 s82, s56, s82
    s_cmp_ge_i32 s88, s82
    s_cbranch_scc1 gate_3_ok
gate_3:
    ds_read_b128 v[36:39], v22 offset:16
    s_waitcnt lgkmcnt(0)
    v_min3_u32 v36, v36, v37, v38
    v_min_u32 v36, v36, v39
    s_nop 0
    v_readfirstlane_b32 s88, v36
    s_add_u32 s63, s63, 1
    s_cmp_ge_i32 s88, s82
    s_cbranch_scc1 gate_3_ok
    s_cmp_gt_u32 s63, 300000
    s_cbranch_scc0 gate_3
gate_3_ok:
    s_mul_i32 s80, s83, 12288
    s_add_u32 s80, s80, s66
    s_add_u32 m0, s80, 0x0
    s_add_u32 s56, s53, 0x0
    buffer_load_dwordx4 v4, s[12:15], s56 offen lds
    s_add_u32 m0, s80, 0x400
    s_add_u32 s56, s53, 0x0
    buffer_load_dwordx4 v5, s[12:15], s56 offen lds
    s_add_u32 m0, s80, 0x800
    s_add_u32 s56, s53, 0x0
    buffer_load_dwordx4 v6, s[12:15], s56 offen lds
    s_add_u32 s53, s53, 393216
    s_add_u32 s62, s62, 1
    s_add_u32 s78, s78, 1
    s_add_u32 s83, s83, 1
    s_cmp_eq_u32 s83, 7
    s_cselect_b32 s83, 0, s83
    s_sub_i32 s82, s78, 6
    s_add_i32 s56, s82, 3
    s_cmp_ge_i32 s78, 27
    s_cselect_b32 s82, s56, s82
    s_cmp_ge_i32 s88, s82
    s_cbranch_scc1 gate_4_ok
gate_4:
    ds_read_b128 v[36:39], v22 offset:16
    s_waitcnt lgkmcnt(0)
    v_min3_u32 v36, v36, v37, v38
    v_min_u32 v36, v36, v39
    s_nop 0
    v_readfirstlane_b32 s88, v36
    s_add_u32 s63, s63, 1
    s_cmp_ge_i32 s88, s82
    s_cbranch_scc1 gate_4_ok
    s_cmp_gt_u32 s63, 300000
    s_cbranch_scc0 gate_4
gate_4_ok:
    s_mul_i32 s80, s83, 12288
    s_add_u32 s80, s80, s66
    s_add_u32 m0, s80, 0x0
    s_add_u32 s56, s53, 0x0
    buffer_load_dwordx4 v4, s[12:15], s56 offen lds
    s_add_u32 m0, s80, 0x400
    s_add_u32 s56, s53, 0x0
    buffer_load_dwordx4 v5, s[12:15], s56 offen lds
    s_add_u32 m0, s80, 0x800
    s_add_u32 s56, s53, 0x0
    buffer_load_dwordx4 v6, s[12:15], s56 offen lds
    s_add_u32 s53, s53, 393216
    s_lshl_b32 s56, s62, 2
    s_mov_b32 m0, s57
    s_mov_b64 exec, 1
    buffer_load_dword v45, s[84:87], s56 offen lds
    s_mov_b64 exec, -1
    s_add_u32 s62, s62, 1
    s_add_u32 s78, s78, 1
    s_add_u32 s83, s83, 1
    s_cmp_eq_u32 s83, 7
    s_cselect_b32 s83, 0, s83
    s_add_u32 s56, s76, 4096
    s_add_u32 s56, s68, 0
    s_cmp_lg_u32 s58, 3
    s_cbranch_scc1 nn_5
    s_cmp_lg_u32 s2, 0
    s_cbranch_scc1 nn_5
    s_memrealtime s[60:61]
    s_waitcnt lgkmcnt(0)
    s_or_b32 s60, s60, 1
    v_mov_b32 v33, s60
    v_mov_b32 v32, 0
    s_mov_b64 exec, 1
    buffer_store_dword v33, v32, s[36:39], 0 offen sc1
    s_mov_b64 exec, -1
nn_5:
    v_add_u32 v32, 0, v0
    s_lshl_b32 s56, s101, 6
    v_add_u32 v32, s56, v32
    v_mul_u32_u24 v33, 0xccd, v32
    v_lshrrev_b32 v33, 16, v33
    v_mul_u32_u24 v34, 20, v33
    v_sub_u32 v34, v32, v34
    v_mul_u32_u24 v35, 1280, v33
    v_lshl_add_u32 v10, v34, 4, v35
    v_add_u32 v32, 64, v0
    s_lshl_b32 s56, s101, 6
    v_add_u32 v32, s56, v32
    v_mul_u32_u24 v33, 0xccd, v32
    v_lshrrev_b32 v33, 16, v33
    v_mul_u32_u24 v34, 20, v33
    v_sub_u32 v34, v32, v34
    v_mul_u32_u24 v35, 1280, v33
    v_lshl_add_u32 v11, v34, 4, v35
    v_add_u32 v32, 128, v0
    s_lshl_b32 s56, s101, 6
    v_add_u32 v32, s56, v32
    v_mul_u32_u24 v33, 0xccd, v32
    v_lshrrev_b32 v33, 16, v33
    v_mul_u32_u24 v34, 20, v33
    v_sub_u32 v34, v32, v34
    v_mul_u32_u24 v35, 1280, v33
    v_lshl_add_u32 v12, v34, 4, v35
    s_lshl_b32 s64, s6, 2
    s_add_u32 s64, s64, s58
    s_lshl_b32 s64, s64, 5
    s_lshl_b32 s56, s5, 3
    s_add_u32 s54, s64, s56
    s_lshl_b32 s56, s43, 2
    s_add_u32 s54, s54, s56
    s_mul_i32 s54, s54, 12288
    s_add_u32 s64, s64, s46
    s_mul_i32 s64, s64, 12288
    s_mov_b32 s69, s64
    s_lshl_b32 s55, s5, 3
    s_lshl_b32 s56, s43, 2
    s_add_u32 s55, s55, s56
    s_mul_i32 s55, s55, 192
    s_mul_i32 s55, s55, 1280
    s_mul_i32 s56, s42, 320
    s_add_u32 s55, s55, s56
    s_cmp_ge_u32 s58, 2
    s_cbranch_scc0 phv_6
    s_mov_b32 s72, s24
    s_mov_b32 s73, s25
    s_mov_b32 s74, s26
    s_mov_b32 s75, s27
    s_mul_i32 s70, s5, 1966080
    s_mul_i32 s56, s41, 7680
    s_add_u32 s70, s70, s56
    s_sub_u32 s56, s58, 2
    s_mul_i32 s56, s56, 3584
    s_add_u32 s70, s70, s56
    s_mov_b32 s71, 245760
    s_branch phe_7
phv_6:
    s_mov_b32 s72, s20
    s_mov_b32 s73, s21
    s_mov_b32 s74, s22
    s_mov_b32 s75, s23
    s_lshl_b32 s70, s6, 2
    s_lshr_b32 s56, s7, 1
    s_add_u32 s70, s70, s56
    s_lshl_b32 s70, s70, 5
    s_lshl_b32 s56, s5, 3
    s_add_u32 s70, s70, s56
    s_mul_i32 s70, s70, 12288
    s_and_b32 s56, s7, 1
    s_mul_i32 s56, s56, 6144
    s_add_u32 s70, s70, s56
    s_lshl_b32 s56, s58, 11
    s_add_u32 s70, s70, s56
    s_mov_b32 s71, 12288
phe_7:
    s_mov_b32 s100, 0
    s_and_b32 s92, s41, 0
    s_add_u32 s56, s76, 4096
    s_add_u32 s56, s68, 1572864
nb_8:
    s_sub_i32 s56, s77, 4
    s_lshl_b32 s82, s56, 1
    s_add_i32 s82, s82, 2
    s_add_i32 s89, s56, 11
    s_cmp_ge_i32 s56, 10
    s_cselect_b32 s82, s89, s82
    s_lshl_b32 s89, s56, 1
    s_sub_i32 s89, s89, 1
    s_cmp_ge_i32 s56, 13
    s_cselect_b32 s82, s89, s82
    s_cmp_ge_i32 s88, s82
    s_cbranch_scc1 gate_9_ok
gate_9:
    ds_read_b128 v[36:39], v22 offset:16
    s_waitcnt lgkmcnt(0)
    v_min3_u32 v36, v36, v37, v38
    v_min_u32 v36, v36, v39
    s_nop 0
    v_readfirstlane_b32 s88, v36
    s_add_u32 s63, s63, 1
    s_cmp_ge_i32 s88, s82
    s_cbranch_scc1 gate_9_ok
    s_cmp_gt_u32 s63, 300000
    s_cbranch_scc0 gate_9
gate_9_ok:
    s_waitcnt vmcnt(24)
    s_lshl_b32 s79, s94, 14
    s_add_u32 s79, s79, s65
    s_add_u32 s94, s94, 1
    s_cmp_eq_u32 s94, 4
    s_cselect_b32 s94, 0, s94
    s_add_u32 m0, s79, 0x0
    s_add_u32 s56, s52, 0x0
    buffer_load_dwordx4 v2, s[8:11], s56 offen lds
    s_add_u32 m0, s79, 0x400
    s_add_u32 s56, s52, 0x2800
    buffer_load_dwordx4 v3, s[8:11], s56 offen lds
    s_add_u32 m0, s79, 0x800
    s_add_u32 s56, s52, 0x5000
    buffer_load_dwordx4 v2, s[8:11], s56 offen lds
    s_add_u32 m0, s79, 0xc00
    s_add_u32 s56, s52, 0x7800
    buffer_load_dwordx4 v3, s[8:11], s56 offen lds
    s_add_u32 s62, s62, 1
    s_add_u32 s77, s77, 1
    s_add_u32 s52, s52, 128
    s_sub_i32 s82, s78, 6
    s_add_i32 s56, s82, 3
    s_cmp_ge_i32 s78, 27
    s_cselect_b32 s82, s56, s82
    s_cmp_ge_i32 s88, s82
    s_cbranch_scc1 gate_10_ok
gate_10:
    ds_read_b128 v[36:39], v22 offset:16
    s_waitcnt lgkmcnt(0)
    v_min3_u32 v36, v36, v37, v38
    v_min_u32 v36, v36, v39
    s_nop 0
    v_readfirstlane_b32 s88, v36
    s_add_u32 s63, s63, 1
    s_cmp_ge_i32 s88, s82
    s_cbranch_scc1 gate_10_ok
    s_cmp_gt_u32 s63, 300000
    s_cbranch_scc0 gate_10
gate_10_ok:
    s_mul_i32 s80, s83, 12288
    s_add_u32 s80, s80, s66
    s_add_u32 m0, s80, 0x0
    s_add_u32 s56, s53, 0x0
    buffer_load_dwordx4 v4, s[12:15], s56 offen lds
    s_add_u32 m0, s80, 0x400
    s_add_u32 s56, s53, 0x0
    buffer_load_dwordx4 v5, s[12:15], s56 offen lds
    s_add_u32 m0, s80, 0x800
    s_add_u32 s56, s53, 0x0
    buffer_load_dwordx4 v6, s[12:15], s56 offen lds
    s_add_u32 s53, s53, 393216
    s_add_u32 s62, s62, 1
    s_add_u32 s78, s78, 1
    s_add_u32 s83, s83, 1
    s_cmp_eq_u32 s83, 7
    s_cselect_b32 s83, 0, s83
    s_sub_i32 s82, s78, 6
    s_add_i32 s56, s82, 3
    s_cmp_ge_i32 s78, 27
    s_cselect_b32 s82, s56, s82
    s_cmp_ge_i32 s88, s82
    s_cbranch_scc1 gate_11_ok
gate_11:
    ds_read_b128 v[36:39], v22 offset:16
    s_waitcnt lgkmcnt(0)
    v_min3_u32 v36, v36, v37, v38
    v_min_u32 v36, v36, v39
    s_nop 0
    v_readfirstlane_b32 s88, v36
    s_add_u32 s63, s63, 1
    s_cmp_ge_i32 s88, s82
    s_cbranch_scc1 gate_11_ok
    s_cmp_gt_u32 s63, 300000
    s_cbranch_scc0 gate_11
gate_11_ok:
    s_mul_i32 s80, s83, 12288
    s_add_u32 s80, s80, s66
    s_add_u32 m0, s80, 0x0
    s_add_u32 s56, s53, 0x0
    buffer_load_dwordx4 v4, s[12:15], s56 offen lds
    s_add_u32 m0, s80, 0x400
    s_add_u32 s56, s53, 0x0
    buffer_load_dwordx4 v5, s[12:15], s56 offen lds
    s_add_u32 m0, s80, 0x800
    s_add_u32 s56, s53, 0x0
    buffer_load_dwordx4 v6, s[12:15], s56 offen lds
    s_add_u32 s53, s53, 393216
    s_lshl_b32 s56, s62, 2
    s_mov_b32 m0, s57
    s_mov_b64 exec, 1
    buffer_load_dword v45, s[84:87], s56 offen lds
    s_mov_b64 exec, -1
    s_add_u32 s62, s62, 1
    s_add_u32 s78, s78, 1
    s_add_u32 s83, s83, 1
    s_cmp_eq_u32 s83, 7
    s_cselect_b32 s83, 0, s83
    s_sub_i32 s56, s77, 4
    s_lshl_b32 s82, s56, 1
    s_add_i32 s82, s82, 2
    s_add_i32 s89, s56, 11
    s_cmp_ge_i32 s56, 10
    s_cselect_b32 s82, s89, s82
    s_lshl_b32 s89, s56, 1
    s_sub_i32 s89, s89, 1
    s_cmp_ge_i32 s56, 13
    s_cselect_b32 s82, s89, s82
    s_cmp_ge_i32 s88, s82
    s_cbranch_scc1 gate_12_ok
gate_12:
    ds_read_b128 v[36:39], v22 offset:16
    s_waitcnt lgkmcnt(0)
    v_min3_u32 v36, v36, v37, v38
    v_min_u32 v36, v36, v39
    s_nop 0
    v_readfirstlane_b32 s88, v36
    s_add_u32 s63, s63, 1
    s_cmp_ge_i32 s88, s82
    s_cbranch_scc1 gate_12_ok
    s_cmp_gt_u32 s63, 300000
    s_cbranch_scc0 gate_12
gate_12_ok:
    s_waitcnt vmcnt(24)
    s_lshl_b32 s79, s94, 14
    s_add_u32 s79, s79, s65
    s_add_u32 s94, s94, 1
    s_cmp_eq_u32 s94, 4
    s_cselect_b32 s94, 0, s94
    s_add_u32 m0, s79, 0x0
    s_add_u32 s56, s52, 0x0
    buffer_load_dwordx4 v2, s[8:11], s56 offen lds
    s_add_u32 m0, s79, 0x400
    s_add_u32 s56, s52, 0x2800
    buffer_load_dwordx4 v3, s[8:11], s56 offen lds
    s_add_u32 m0, s79, 0x800
    s_add_u32 s56, s52, 0x5000
    buffer_load_dwordx4 v2, s[8:11], s56 offen lds
    s_add_u32 m0, s79, 0xc00
    s_add_u32 s56, s52, 0x7800
    buffer_load_dwordx4 v3, s[8:11], s56 offen lds
    s_add_u32 s62, s62, 1
    s_add_u32 s77, s77, 1
    s_add_u32 s52, s52, 128
    s_sub_i32 s82, s78, 6
    s_add_i32 s56, s82, 3
    s_cmp_ge_i32 s78, 27
    s_cselect_b32 s82, s56, s82
    s_cmp_ge_i32 s88, s82
    s_cbranch_scc1 gate_13_ok
gate_13:
    ds_read_b128 v[36:39], v22 offset:16
    s_waitcnt lgkmcnt(0)
    v_min3_u32 v36, v36, v37, v38
    v_min_u32 v36, v36, v39
    s_nop 0
    v_readfirstlane_b32 s88, v36
    s_add_u32 s63, s63, 1
    s_cmp_ge_i32 s88, s82
    s_cbranch_scc1 gate_13_ok
    s_cmp_gt_u32 s63, 300000
    s_cbranch_scc0 gate_13
gate_13_ok:
    s_mul_i32 s80, s83, 12288
    s_add_u32 s80, s80, s66
    s_add_u32 m0, s80, 0x0
    s_add_u32 s56, s53, 0x0
    buffer_load_dwordx4 v4, s[12:15], s56 offen lds
    s_add_u32 m0, s80, 0x400
    s_add_u32 s56, s53, 0x0
    buffer_load_dwordx4 v5, s[12:15], s56 offen lds
    s_add_u32 m0, s80, 0x800
    s_add_u32 s56, s53, 0x0
    buffer_load_dwordx4 v6, s[12:15], s56 offen lds
    s_add_u32 s53, s53, 393216
    s_add_u32 s62, s62, 1
    s_add_u32 s78, s78, 1
    s_add_u32 s83, s83, 1
    s_cmp_eq_u32 s83, 7
    s_cselect_b32 s83, 0, s83
    s_sub_i32 s82, s78, 6
    s_add_i32 s56, s82, 3
    s_cmp_ge_i32 s78, 27
    s_cselect_b32 s82, s56, s82
    s_cmp_ge_i32 s88, s82
    s_cbranch_scc1 gate_14_ok
gate_14:
    ds_read_b128 v[36:39], v22 offset:16
    s_waitcnt lgkmcnt(0)
    v_min3_u32 v36, v36, v37, v38
    v_min_u32 v36, v36, v39
    s_nop 0
    v_readfirstlane_b32 s88, v36
    s_add_u32 s63, s63, 1
    s_cmp_ge_i32 s88, s82
    s_cbranch_scc1 gate_14_ok
    s_cmp_gt_u32 s63, 300000
    s_cbranch_scc0 gate_14
gate_14_ok:
    s_mul_i32 s80, s83, 12288
    s_add_u32 s80, s80, s66
    s_add_u32 m0, s80, 0x0
    s_add_u32 s56, s53, 0x0
    buffer_load_dwordx4 v4, s[12:15], s56 offen lds
    s_add_u32 m0, s80, 0x400
    s_add_u32 s56, s53, 0x0
    buffer_load_dwordx4 v5, s[12:15], s56 offen lds
    s_add_u32 m0, s80, 0x800
    s_add_u32 s56, s53, 0x0
    buffer_load_dwordx4 v6, s[12:15], s56 offen lds
    s_add_u32 s53, s53, 393216
    s_lshl_b32 s56, s62, 2
    s_mov_b32 m0, s57
    s_mov_b64 exec, 1
    buffer_load_dword v45, s[84:87], s56 offen lds
    s_mov_b64 exec, -1
    s_add_u32 s62, s62, 1
    s_add_u32 s78, s78, 1
    s_add_u32 s83, s83, 1
    s_cmp_eq_u32 s83, 7
    s_cselect_b32 s83, 0, s83
    s_add_u32 s56, s68, 3145728
    s_add_u32 s56, s68, 4718592
nb_15:
    s_sub_i32 s56, s77, 4
    s_lshl_b32 s82, s56, 1
    s_add_i32 s82, s82, 2
    s_add_i32 s89, s56, 11
    s_cmp_ge_i32 s56, 10
    s_cselect_b32 s82, s89, s82
    s_lshl_b32 s89, s56, 1
    s_sub_i32 s89, s89, 1
    s_cmp_ge_i32 s56, 13
    s_cselect_b32 s82, s89, s82
    s_cmp_ge_i32 s88, s82
    s_cbranch_scc1 gate_16_ok
gate_16:
    ds_read_b128 v[36:39], v22 offset:16
    s_waitcnt lgkmcnt(0)
    v_min3_u32 v36, v36, v37, v38
    v_min_u32 v36, v36, v39
    s_nop 0
    v_readfirstlane_b32 s88, v36
    s_add_u32 s63, s63, 1
    s_cmp_ge_i32 s88, s82
    s_cbranch_scc1 gate_16_ok
    s_cmp_gt_u32 s63, 300000
    s_cbranch_scc0 gate_16
gate_16_ok:
    s_waitcnt vmcnt(24)
    s_lshl_b32 s79, s94, 14
    s_add_u32 s79, s79, s65
    s_add_u32 s94, s94, 1
    s_cmp_eq_u32 s94, 4
    s_cselect_b32 s94, 0, s94
    s_add_u32 m0, s79, 0x0
    s_add_u32 s56, s52, 0x0
    buffer_load_dwordx4 v2, s[8:11], s56 offen lds
    s_add_u32 m0, s79, 0x400
    s_add_u32 s56, s52, 0x2800
    buffer_load_dwordx4 v3, s[8:11], s56 offen lds
    s_add_u32 m0, s79, 0x800
    s_add_u32 s56, s52, 0x5000
    buffer_load_dwordx4 v2, s[8:11], s56 offen lds
    s_add_u32 m0, s79, 0xc00
    s_add_u32 s56, s52, 0x7800
    buffer_load_dwordx4 v3, s[8:11], s56 offen lds
    s_add_u32 s62, s62, 1
    s_add_u32 s77, s77, 1
    s_add_u32 s52, s52, 128
    s_sub_i32 s82, s78, 6
    s_add_i32 s56, s82, 3
    s_cmp_ge_i32 s78, 27
    s_cselect_b32 s82, s56, s82
    s_cmp_ge_i32 s88, s82
    s_cbranch_scc1 gate_17_ok
gate_17:
    ds_read_b128 v[36:39], v22 offset:16
    s_waitcnt lgkmcnt(0)
    v_min3_u32 v36, v36, v37, v38
    v_min_u32 v36, v36, v39
    s_nop 0
    v_readfirstlane_b32 s88, v36
    s_add_u32 s63, s63, 1
    s_cmp_ge_i32 s88, s82
    s_cbranch_scc1 gate_17_ok
    s_cmp_gt_u32 s63, 300000
    s_cbranch_scc0 gate_17
gate_17_ok:
    s_mul_i32 s80, s83, 12288
    s_add_u32 s80, s80, s66
    s_add_u32 m0, s80, 0x0
    s_add_u32 s56, s53, 0x0
    buffer_load_dwordx4 v4, s[12:15], s56 offen lds
    s_add_u32 m0, s80, 0x400
    s_add_u32 s56, s53, 0x0
    buffer_load_dwordx4 v5, s[12:15], s56 offen lds
    s_add_u32 m0, s80, 0x800
    s_add_u32 s56, s53, 0x0
    buffer_load_dwordx4 v6, s[12:15], s56 offen lds
    s_add_u32 s53, s53, 393216
    s_add_u32 s62, s62, 1
    s_add_u32 s78, s78, 1
    s_add_u32 s83, s83, 1
    s_cmp_eq_u32 s83, 7
    s_cselect_b32 s83, 0, s83
    s_sub_i32 s82, s78, 6
    s_add_i32 s56, s82, 3
    s_cmp_ge_i32 s78, 27
    s_cselect_b32 s82, s56, s82
    s_cmp_ge_i32 s88, s82
    s_cbranch_scc1 gate_18_ok
gate_18:
    ds_read_b128 v[36:39], v22 offset:16
    s_waitcnt lgkmcnt(0)
    v_min3_u32 v36, v36, v37, v38
    v_min_u32 v36, v36, v39
    s_nop 0
    v_readfirstlane_b32 s88, v36
    s_add_u32 s63, s63, 1
    s_cmp_ge_i32 s88, s82
    s_cbranch_scc1 gate_18_ok
    s_cmp_gt_u32 s63, 300000
    s_cbranch_scc0 gate_18
gate_18_ok:
    s_mul_i32 s80, s83, 12288
    s_add_u32 s80, s80, s66
    s_add_u32 m0, s80, 0x0
    s_add_u32 s56, s53, 0x0
    buffer_load_dwordx4 v4, s[12:15], s56 offen lds
    s_add_u32 m0, s80, 0x400
    s_add_u32 s56, s53, 0x0
    buffer_load_dwordx4 v5, s[12:15], s56 offen lds
    s_add_u32 m0, s80, 0x800
    s_add_u32 s56, s53, 0x0
    buffer_load_dwordx4 v6, s[12:15], s56 offen lds
    s_add_u32 s53, s53, 393216
    s_lshl_b32 s56, s62, 2
    s_mov_b32 m0, s57
    s_mov_b64 exec, 1
    buffer_load_dword v45, s[84:87], s56 offen lds
    s_mov_b64 exec, -1
    s_add_u32 s62, s62, 1
    s_add_u32 s78, s78, 1
    s_add_u32 s83, s83, 1
    s_cmp_eq_u32 s83, 7
    s_cselect_b32 s83, 0, s83
    s_sub_i32 s56, s77, 4
    s_lshl_b32 s82, s56, 1
    s_add_i32 s82, s82, 2
    s_add_i32 s89, s56, 11
    s_cmp_ge_i32 s56, 10
    s_cselect_b32 s82, s89, s82
    s_lshl_b32 s89, s56, 1
    s_sub_i32 s89, s89, 1
    s_cmp_ge_i32 s56, 13
    s_cselect_b32 s82, s89, s82
    s_cmp_ge_i32 s88, s82
    s_cbranch_scc1 gate_19_ok
gate_19:
    ds_read_b128 v[36:39], v22 offset:16
    s_waitcnt lgkmcnt(0)
    v_min3_u32 v36, v36, v37, v38
    v_min_u32 v36, v36, v39
    s_nop 0
    v_readfirstlane_b32 s88, v36
    s_add_u32 s63, s63, 1
    s_cmp_ge_i32 s88, s82
    s_cbranch_scc1 gate_19_ok
    s_cmp_gt_u32 s63, 300000
    s_cbranch_scc0 gate_19
gate_19_ok:
    s_waitcnt vmcnt(24)
    s_lshl_b32 s79, s94, 14
    s_add_u32 s79, s79, s65
    s_add_u32 s94, s94, 1
    s_cmp_eq_u32 s94, 4
    s_cselect_b32 s94, 0, s94
    s_add_u32 m0, s79, 0x0
    s_add_u32 s56, s52, 0x0
    buffer_load_dwordx4 v2, s[8:11], s56 offen lds
    s_add_u32 m0, s79, 0x400
    s_add_u32 s56, s52, 0x2800
    buffer_load_dwordx4 v3, s[8:11], s56 offen lds
    s_add_u32 m0, s79, 0x800
    s_add_u32 s56, s52, 0x5000
    buffer_load_dwordx4 v2, s[8:11], s56 offen lds
    s_add_u32 m0, s79, 0xc00
    s_add_u32 s56, s52, 0x7800
    buffer_load_dwordx4 v3, s[8:11], s56 offen lds
    s_add_u32 s62, s62, 1
    s_add_u32 s77, s77, 1
    s_add_u32 s52, s52, 128
    s_sub_i32 s82, s78, 6
    s_add_i32 s56, s82, 3
    s_cmp_ge_i32 s78, 27
    s_cselect_b32 s82, s56, s82
    s_cmp_ge_i32 s88, s82
    s_cbranch_scc1 gate_20_ok
gate_20:
    ds_read_b128 v[36:39], v22 offset:16
    s_waitcnt lgkmcnt(0)
    v_min3_u32 v36, v36, v37, v38
    v_min_u32 v36, v36, v39
    s_nop 0
    v_readfirstlane_b32 s88, v36
    s_add_u32 s63, s63, 1
    s_cmp_ge_i32 s88, s82
    s_cbranch_scc1 gate_20_ok
    s_cmp_gt_u32 s63, 300000
    s_cbranch_scc0 gate_20
gate_20_ok:
    s_mul_i32 s80, s83, 12288
    s_add_u32 s80, s80, s66
    s_add_u32 m0, s80, 0x0
    s_add_u32 s56, s53, 0x0
    buffer_load_dwordx4 v4, s[12:15], s56 offen lds
    s_add_u32 m0, s80, 0x400
    s_add_u32 s56, s53, 0x0
    buffer_load_dwordx4 v5, s[12:15], s56 offen lds
    s_add_u32 m0, s80, 0x800
    s_add_u32 s56, s53, 0x0
    buffer_load_dwordx4 v6, s[12:15], s56 offen lds
    s_add_u32 s53, s53, 393216
    s_add_u32 s62, s62, 1
    s_add_u32 s78, s78, 1
    s_add_u32 s83, s83, 1
    s_cmp_eq_u32 s83, 7
    s_cselect_b32 s83, 0, s83
    s_sub_i32 s82, s78, 6
    s_add_i32 s56, s82, 3
    s_cmp_ge_i32 s78, 27
    s_cselect_b32 s82, s56, s82
    s_cmp_ge_i32 s88, s82
    s_cbranch_scc1 gate_21_ok
gate_21:
    ds_read_b128 v[36:39], v22 offset:16
    s_waitcnt lgkmcnt(0)
    v_min3_u32 v36, v36, v37, v38
    v_min_u32 v36, v36, v39
    s_nop 0
    v_readfirstlane_b32 s88, v36
    s_add_u32 s63, s63, 1
    s_cmp_ge_i32 s88, s82
    s_cbranch_scc1 gate_21_ok
    s_cmp_gt_u32 s63, 300000
    s_cbranch_scc0 gate_21
gate_21_ok:
    s_mul_i32 s80, s83, 12288
    s_add_u32 s80, s80, s66
    s_add_u32 m0, s80, 0x0
    s_add_u32 s56, s53, 0x0
    buffer_load_dwordx4 v4, s[12:15], s56 offen lds
    s_add_u32 m0, s80, 0x400
    s_add_u32 s56, s53, 0x0
    buffer_load_dwordx4 v5, s[12:15], s56 offen lds
    s_add_u32 m0, s80, 0x800
    s_add_u32 s56, s53, 0x0
    buffer_load_dwordx4 v6, s[12:15], s56 offen lds
    s_add_u32 s53, s53, 393216
    s_lshl_b32 s56, s62, 2
    s_mov_b32 m0, s57
    s_mov_b64 exec, 1
    buffer_load_dword v45, s[84:87], s56 offen lds
    s_mov_b64 exec, -1
    s_add_u32 s62, s62, 1
    s_add_u32 s78, s78, 1
    s_add_u32 s83, s83, 1
    s_cmp_eq_u32 s83, 7
    s_cselect_b32 s83, 0, s83
    s_sub_i32 s56, s77, 4
    s_lshl_b32 s82, s56, 1
    s_add_i32 s82, s82, 2
    s_add_i32 s89, s56, 11
    s_cmp_ge_i32 s56, 10
    s_cselect_b32 s82, s89, s82
    s_lshl_b32 s89, s56, 1
    s_sub_i32 s89, s89, 1
    s_cmp_ge_i32 s56, 13
    s_cselect_b32 s82, s89, s82
    s_cmp_ge_i32 s88, s82
    s_cbranch_scc1 gate_22_ok
gate_22:
    ds_read_b128 v[36:39], v22 offset:16
    s_waitcnt lgkmcnt(0)
    v_min3_u32 v36, v36, v37, v38
    v_min_u32 v36, v36, v39
    s_nop 0
    v_readfirstlane_b32 s88, v36
    s_add_u32 s63, s63, 1
    s_cmp_ge_i32 s88, s82
    s_cbranch_scc1 gate_22_ok
    s_cmp_gt_u32 s63, 300000
    s_cbranch_scc0 gate_22
gate_22_ok:
    s_waitcnt vmcnt(24)
    s_lshl_b32 s79, s94, 14
    s_add_u32 s79, s79, s65
    s_add_u32 s94, s94, 1
    s_cmp_eq_u32 s94, 4
    s_cselect_b32 s94, 0, s94
    s_add_u32 m0, s79, 0x0
    s_add_u32 s56, s52, 0x0
    buffer_load_dwordx4 v2, s[8:11], s56 offen lds
    s_add_u32 m0, s79, 0x400
    s_add_u32 s56, s52, 0x2800
    buffer_load_dwordx4 v3, s[8:11], s56 offen lds
    s_add_u32 m0, s79, 0x800
    s_add_u32 s56, s52, 0x5000
    buffer_load_dwordx4 v2, s[8:11], s56 offen lds
    s_add_u32 m0, s79, 0xc00
    s_add_u32 s56, s52, 0x7800
    buffer_load_dwordx4 v3, s[8:11], s56 offen lds
    s_add_u32 s62, s62, 1
    s_add_u32 s77, s77, 1
    s_add_u32 s52, s52, 128
    s_sub_i32 s82, s78, 6
    s_add_i32 s56, s82, 3
    s_cmp_ge_i32 s78, 27
    s_cselect_b32 s82, s56, s82
    s_cmp_ge_i32 s88, s82
    s_cbranch_scc1 gate_23_ok
gate_23:
    ds_read_b128 v[36:39], v22 offset:16
    s_waitcnt lgkmcnt(0)
    v_min3_u32 v36, v36, v37, v38
    v_min_u32 v36, v36, v39
    s_nop 0
    v_readfirstlane_b32 s88, v36
    s_add_u32 s63, s63, 1
    s_cmp_ge_i32 s88, s82
    s_cbranch_scc1 gate_23_ok
    s_cmp_gt_u32 s63, 300000
    s_cbranch_scc0 gate_23
gate_23_ok:
    s_mul_i32 s80, s83, 12288
    s_add_u32 s80, s80, s66
    s_add_u32 m0, s80, 0x0
    s_add_u32 s56, s53, 0x0
    buffer_load_dwordx4 v4, s[12:15], s56 offen lds
    s_add_u32 m0, s80, 0x400
    s_add_u32 s56, s53, 0x0
    buffer_load_dwordx4 v5, s[12:15], s56 offen lds
    s_add_u32 m0, s80, 0x800
    s_add_u32 s56, s53, 0x0
    buffer_load_dwordx4 v6, s[12:15], s56 offen lds
    s_add_u32 s53, s53, 393216
    s_add_u32 s62, s62, 1
    s_add_u32 s78, s78, 1
    s_add_u32 s83, s83, 1
    s_cmp_eq_u32 s83, 7
    s_cselect_b32 s83, 0, s83
    s_sub_i32 s82, s78, 6
    s_add_i32 s56, s82, 3
    s_cmp_ge_i32 s78, 27
    s_cselect_b32 s82, s56, s82
    s_cmp_ge_i32 s88, s82
    s_cbranch_scc1 gate_24_ok
gate_24:
    ds_read_b128 v[36:39], v22 offset:16
    s_waitcnt lgkmcnt(0)
    v_min3_u32 v36, v36, v37, v38
    v_min_u32 v36, v36, v39
    s_nop 0
    v_readfirstlane_b32 s88, v36
    s_add_u32 s63, s63, 1
    s_cmp_ge_i32 s88, s82
    s_cbranch_scc1 gate_24_ok
    s_cmp_gt_u32 s63, 300000
    s_cbranch_scc0 gate_24
gate_24_ok:
    s_mul_i32 s80, s83, 12288
    s_add_u32 s80, s80, s66
    s_add_u32 m0, s80, 0x0
    s_add_u32 s56, s53, 0x0
    buffer_load_dwordx4 v4, s[12:15], s56 offen lds
    s_add_u32 m0, s80, 0x400
    s_add_u32 s56, s53, 0x0
    buffer_load_dwordx4 v5, s[12:15], s56 offen lds
    s_add_u32 m0, s80, 0x800
    s_add_u32 s56, s53, 0x0
    buffer_load_dwordx4 v6, s[12:15], s56 offen lds
    s_add_u32 s53, s53, 393216
    s_lshl_b32 s56, s62, 2
    s_mov_b32 m0, s57
    s_mov_b64 exec, 1
    buffer_load_dword v45, s[84:87], s56 offen lds
    s_mov_b64 exec, -1
    s_add_u32 s62, s62, 1
    s_add_u32 s78, s78, 1
    s_add_u32 s83, s83, 1
    s_cmp_eq_u32 s83, 7
    s_cselect_b32 s83, 0, s83
    s_mul_i32 s56, s71, 0
    s_add_u32 s56, s56, s70
    s_mul_i32 s56, s71, 4
    s_add_u32 s56, s56, s70
nb_25:
    s_sub_i32 s56, s77, 4
    s_lshl_b32 s82, s56, 1
    s_add_i32 s82, s82, 2
    s_add_i32 s89, s56, 11
    s_cmp_ge_i32 s56, 10
    s_cselect_b32 s82, s89, s82
    s_lshl_b32 s89, s56, 1
    s_sub_i32 s89, s89, 1
    s_cmp_ge_i32 s56, 13
    s_cselect_b32 s82, s89, s82
    s_cmp_ge_i32 s88, s82
    s_cbranch_scc1 gate_26_ok
gate_26:
    ds_read_b128 v[36:39], v22 offset:16
    s_waitcnt lgkmcnt(0)
    v_min3_u32 v36, v36, v37, v38
    v_min_u32 v36, v36, v39
    s_nop 0
    v_readfirstlane_b32 s88, v36
    s_add_u32 s63, s63, 1
    s_cmp_ge_i32 s88, s82
    s_cbranch_scc1 gate_26_ok
    s_cmp_gt_u32 s63, 300000
    s_cbranch_scc0 gate_26
gate_26_ok:
    s_waitcnt vmcnt(24)
    s_lshl_b32 s79, s94, 14
    s_add_u32 s79, s79, s65
    s_add_u32 s94, s94, 1
    s_cmp_eq_u32 s94, 4
    s_cselect_b32 s94, 0, s94
    s_add_u32 m0, s79, 0x0
    s_add_u32 s56, s52, 0x0
    buffer_load_dwordx4 v2, s[8:11], s56 offen lds
    s_add_u32 m0, s79, 0x400
    s_add_u32 s56, s52, 0x2800
    buffer_load_dwordx4 v3, s[8:11], s56 offen lds
    s_add_u32 m0, s79, 0x800
    s_add_u32 s56, s52, 0x5000
    buffer_load_dwordx4 v2, s[8:11], s56 offen lds
    s_add_u32 m0, s79, 0xc00
    s_add_u32 s56, s52, 0x7800
    buffer_load_dwordx4 v3, s[8:11], s56 offen lds
    s_add_u32 s62, s62, 1
    s_add_u32 s77, s77, 1
    s_add_u32 s52, s52, 128
    s_sub_i32 s82, s78, 6
    s_add_i32 s56, s82, 3
    s_cmp_ge_i32 s78, 27
    s_cselect_b32 s82, s56, s82
    s_cmp_ge_i32 s88, s82
    s_cbranch_scc1 gate_27_ok
gate_27:
    ds_read_b128 v[36:39], v22 offset:16
    s_waitcnt lgkmcnt(0)
    v_min3_u32 v36, v36, v37, v38
    v_min_u32 v36, v36, v39
    s_nop 0
    v_readfirstlane_b32 s88, v36
    s_add_u32 s63, s63, 1
    s_cmp_ge_i32 s88, s82
    s_cbranch_scc1 gate_27_ok
    s_cmp_gt_u32 s63, 300000
    s_cbranch_scc0 gate_27
gate_27_ok:
    s_mul_i32 s80, s83, 12288
    s_add_u32 s80, s80, s66
    s_add_u32 m0, s80, 0x0
    s_add_u32 s56, s53, 0x0
    buffer_load_dwordx4 v4, s[12:15], s56 offen lds
    s_add_u32 m0, s80, 0x400
    s_add_u32 s56, s53, 0x0
    buffer_load_dwordx4 v5, s[12:15], s56 offen lds
    s_add_u32 m0, s80, 0x800
    s_add_u32 s56, s53, 0x0
    buffer_load_dwordx4 v6, s[12:15], s56 offen lds
    s_add_u32 s53, s53, 393216
    s_add_u32 s62, s62, 1
    s_add_u32 s78, s78, 1
    s_add_u32 s83, s83, 1
    s_cmp_eq_u32 s83, 7
    s_cselect_b32 s83, 0, s83
    s_sub_i32 s82, s78, 6
    s_add_i32 s56, s82, 3
    s_cmp_ge_i32 s78, 27
    s_cselect_b32 s82, s56, s82
    s_cmp_ge_i32 s88, s82
    s_cbranch_scc1 gate_28_ok
gate_28:
    ds_read_b128 v[36:39], v22 offset:16
    s_waitcnt lgkmcnt(0)
    v_min3_u32 v36, v36, v37, v38
    v_min_u32 v36, v36, v39
    s_nop 0
    v_readfirstlane_b32 s88, v36
    s_add_u32 s63, s63, 1
    s_cmp_ge_i32 s88, s82
    s_cbranch_scc1 gate_28_ok
    s_cmp_gt_u32 s63, 300000
    s_cbranch_scc0 gate_28
gate_28_ok:
    s_mul_i32 s80, s83, 12288
    s_add_u32 s80, s80, s66
    s_add_u32 m0, s80, 0x0
    s_add_u32 s56, s53, 0x0
    buffer_load_dwordx4 v4, s[12:15], s56 offen lds
    s_add_u32 m0, s80, 0x400
    s_add_u32 s56, s53, 0x0
    buffer_load_dwordx4 v5, s[12:15], s56 offen lds
    s_add_u32 m0, s80, 0x800
    s_add_u32 s56, s53, 0x0
    buffer_load_dwordx4 v6, s[12:15], s56 offen lds
    s_add_u32 s53, s53, 393216
    s_lshl_b32 s56, s62, 2
    s_mov_b32 m0, s57
    s_mov_b64 exec, 1
    buffer_load_dword v45, s[84:87], s56 offen lds
    s_mov_b64 exec, -1
    s_add_u32 s62, s62, 1
    s_add_u32 s78, s78, 1
    s_add_u32 s83, s83, 1
    s_cmp_eq_u32 s83, 7
    s_cselect_b32 s83, 0, s83
    s_sub_i32 s56, s77, 4
    s_lshl_b32 s82, s56, 1
    s_add_i32 s82, s82, 2
    s_add_i32 s89, s56, 11
    s_cmp_ge_i32 s56, 10
    s_cselect_b32 s82, s89, s82
    s_lshl_b32 s89, s56, 1
    s_sub_i32 s89, s89, 1
    s_cmp_ge_i32 s56, 13
    s_cselect_b32 s82, s89, s82
    s_cmp_ge_i32 s88, s82
    s_cbranch_scc1 gate_29_ok
gate_29:
    ds_read_b128 v[36:39], v22 offset:16
    s_waitcnt lgkmcnt(0)
    v_min3_u32 v36, v36, v37, v38
    v_min_u32 v36, v36, v39
    s_nop 0
    v_readfirstlane_b32 s88, v36
    s_add_u32 s63, s63, 1
    s_cmp_ge_i32 s88, s82
    s_cbranch_scc1 gate_29_ok
    s_cmp_gt_u32 s63, 300000
    s_cbranch_scc0 gate_29
gate_29_ok:
    s_waitcnt vmcnt(24)
    s_lshl_b32 s79, s94, 14
    s_add_u32 s79, s79, s65
    s_add_u32 s94, s94, 1
    s_cmp_eq_u32 s94, 4
    s_cselect_b32 s94, 0, s94
    s_add_u32 m0, s79, 0x0
    s_add_u32 s56, s52, 0x0
    buffer_load_dwordx4 v2, s[8:11], s56 offen lds
    s_add_u32 m0, s79, 0x400
    s_add_u32 s56, s52, 0x2800
    buffer_load_dwordx4 v3, s[8:11], s56 offen lds
    s_add_u32 m0, s79, 0x800
    s_add_u32 s56, s52, 0x5000
    buffer_load_dwordx4 v2, s[8:11], s56 offen lds
    s_add_u32 m0, s79, 0xc00
    s_add_u32 s56, s52, 0x7800
    buffer_load_dwordx4 v3, s[8:11], s56 offen lds
    s_add_u32 s62, s62, 1
    s_add_u32 s77, s77, 1
    s_add_u32 s52, s52, 128
    s_sub_i32 s82, s78, 6
    s_add_i32 s56, s82, 3
    s_cmp_ge_i32 s78, 27
    s_cselect_b32 s82, s56, s82
    s_cmp_ge_i32 s88, s82
    s_cbranch_scc1 gate_30_ok
gate_30:
    ds_read_b128 v[36:39], v22 offset:16
    s_waitcnt lgkmcnt(0)
    v_min3_u32 v36, v36, v37, v38
    v_min_u32 v36, v36, v39
    s_nop 0
    v_readfirstlane_b32 s88, v36
    s_add_u32 s63, s63, 1
    s_cmp_ge_i32 s88, s82
    s_cbranch_scc1 gate_30_ok
    s_cmp_gt_u32 s63, 300000
    s_cbranch_scc0 gate_30
gate_30_ok:
    s_mul_i32 s80, s83, 12288
    s_add_u32 s80, s80, s66
    s_add_u32 m0, s80, 0x0
    s_add_u32 s56, s53, 0x0
    buffer_load_dwordx4 v4, s[12:15], s56 offen lds
    s_add_u32 m0, s80, 0x400
    s_add_u32 s56, s53, 0x0
    buffer_load_dwordx4 v5, s[12:15], s56 offen lds
    s_add_u32 m0, s80, 0x800
    s_add_u32 s56, s53, 0x0
    buffer_load_dwordx4 v6, s[12:15], s56 offen lds
    s_add_u32 s53, s53, 393216
    s_add_u32 s62, s62, 1
    s_add_u32 s78, s78, 1
    s_add_u32 s83, s83, 1
    s_cmp_eq_u32 s83, 7
    s_cselect_b32 s83, 0, s83
    s_sub_i32 s82, s78, 6
    s_add_i32 s56, s82, 3
    s_cmp_ge_i32 s78, 27
    s_cselect_b32 s82, s56, s82
    s_cmp_ge_i32 s88, s82
    s_cbranch_scc1 gate_31_ok
gate_31:
    ds_read_b128 v[36:39], v22 offset:16
    s_waitcnt lgkmcnt(0)
    v_min3_u32 v36, v36, v37, v38
    v_min_u32 v36, v36, v39
    s_nop 0
    v_readfirstlane_b32 s88, v36
    s_add_u32 s63, s63, 1
    s_cmp_ge_i32 s88, s82
    s_cbranch_scc1 gate_31_ok
    s_cmp_gt_u32 s63, 300000
    s_cbranch_scc0 gate_31
gate_31_ok:
    s_mul_i32 s80, s83, 12288
    s_add_u32 s80, s80, s66
    s_add_u32 m0, s80, 0x0
    s_add_u32 s56, s53, 0x0
    buffer_load_dwordx4 v4, s[12:15], s56 offen lds
    s_add_u32 m0, s80, 0x400
    s_add_u32 s56, s53, 0x0
    buffer_load_dwordx4 v5, s[12:15], s56 offen lds
    s_add_u32 m0, s80, 0x800
    s_add_u32 s56, s53, 0x0
    buffer_load_dwordx4 v6, s[12:15], s56 offen lds
    s_add_u32 s53, s53, 393216
    s_lshl_b32 s56, s62, 2
    s_mov_b32 m0, s57
    s_mov_b64 exec, 1
    buffer_load_dword v45, s[84:87], s56 offen lds
    s_mov_b64 exec, -1
    s_add_u32 s62, s62, 1
    s_add_u32 s78, s78, 1
    s_add_u32 s83, s83, 1
    s_cmp_eq_u32 s83, 7
    s_cselect_b32 s83, 0, s83
    s_sub_i32 s56, s77, 4
    s_lshl_b32 s82, s56, 1
    s_add_i32 s82, s82, 2
    s_add_i32 s89, s56, 11
    s_cmp_ge_i32 s56, 10
    s_cselect_b32 s82, s89, s82
    s_lshl_b32 s89, s56, 1
    s_sub_i32 s89, s89, 1
    s_cmp_ge_i32 s56, 13
    s_cselect_b32 s82, s89, s82
    s_cmp_ge_i32 s88, s82
    s_cbranch_scc1 gate_32_ok
gate_32:
    ds_read_b128 v[36:39], v22 offset:16
    s_waitcnt lgkmcnt(0)
    v_min3_u32 v36, v36, v37, v38
    v_min_u32 v36, v36, v39
    s_nop 0
    v_readfirstlane_b32 s88, v36
    s_add_u32 s63, s63, 1
    s_cmp_ge_i32 s88, s82
    s_cbranch_scc1 gate_32_ok
    s_cmp_gt_u32 s63, 300000
    s_cbranch_scc0 gate_32
gate_32_ok:
    s_waitcnt vmcnt(24)
    s_lshl_b32 s79, s94, 14
    s_add_u32 s79, s79, s65
    s_add_u32 s94, s94, 1
    s_cmp_eq_u32 s94, 4
    s_cselect_b32 s94, 0, s94
    s_add_u32 m0, s79, 0x0
    s_add_u32 s56, s52, 0x0
    buffer_load_dwordx4 v2, s[8:11], s56 offen lds
    s_add_u32 m0, s79, 0x400
    s_add_u32 s56, s52, 0x2800
    buffer_load_dwordx4 v3, s[8:11], s56 offen lds
    s_add_u32 m0, s79, 0x800
    s_add_u32 s56, s52, 0x5000
    buffer_load_dwordx4 v2, s[8:11], s56 offen lds
    s_add_u32 m0, s79, 0xc00
    s_add_u32 s56, s52, 0x7800
    buffer_load_dwordx4 v3, s[8:11], s56 offen lds
    s_add_u32 s62, s62, 1
    s_add_u32 s77, s77, 1
    s_add_u32 s52, s52, 128
    s_sub_i32 s82, s78, 6
    s_add_i32 s56, s82, 3
    s_cmp_ge_i32 s78, 27
    s_cselect_b32 s82, s56, s82
    s_cmp_ge_i32 s88, s82
    s_cbranch_scc1 gate_33_ok
gate_33:
    ds_read_b128 v[36:39], v22 offset:16
    s_waitcnt lgkmcnt(0)
    v_min3_u32 v36, v36, v37, v38
    v_min_u32 v36, v36, v39
    s_nop 0
    v_readfirstlane_b32 s88, v36
    s_add_u32 s63, s63, 1
    s_cmp_ge_i32 s88, s82
    s_cbranch_scc1 gate_33_ok
    s_cmp_gt_u32 s63, 300000
    s_cbranch_scc0 gate_33
gate_33_ok:
    s_mul_i32 s80, s83, 12288
    s_add_u32 s80, s80, s66
    s_add_u32 m0, s80, 0x0
    s_add_u32 s56, s53, 0x0
    buffer_load_dwordx4 v4, s[12:15], s56 offen lds
    s_add_u32 m0, s80, 0x400
    s_add_u32 s56, s53, 0x0
    buffer_load_dwordx4 v5, s[12:15], s56 offen lds
    s_add_u32 m0, s80, 0x800
    s_add_u32 s56, s53, 0x0
    buffer_load_dwordx4 v6, s[12:15], s56 offen lds
    s_add_u32 s53, s53, 393216
    s_add_u32 s62, s62, 1
    s_add_u32 s78, s78, 1
    s_add_u32 s83, s83, 1
    s_cmp_eq_u32 s83, 7
    s_cselect_b32 s83, 0, s83
    s_sub_i32 s82, s78, 6
    s_add_i32 s56, s82, 3
    s_cmp_ge_i32 s78, 27
    s_cselect_b32 s82, s56, s82
    s_cmp_ge_i32 s88, s82
    s_cbranch_scc1 gate_34_ok
gate_34:
    ds_read_b128 v[36:39], v22 offset:16
    s_waitcnt lgkmcnt(0)
    v_min3_u32 v36, v36, v37, v38
    v_min_u32 v36, v36, v39
    s_nop 0
    v_readfirstlane_b32 s88, v36
    s_add_u32 s63, s63, 1
    s_cmp_ge_i32 s88, s82
    s_cbranch_scc1 gate_34_ok
    s_cmp_gt_u32 s63, 300000
    s_cbranch_scc0 gate_34
gate_34_ok:
    s_mul_i32 s80, s83, 12288
    s_add_u32 s80, s80, s66
    s_add_u32 m0, s80, 0x0
    s_add_u32 s56, s53, 0x0
    buffer_load_dwordx4 v4, s[12:15], s56 offen lds
    s_add_u32 m0, s80, 0x400
    s_add_u32 s56, s53, 0x0
    buffer_load_dwordx4 v5, s[12:15], s56 offen lds
    s_add_u32 m0, s80, 0x800
    s_add_u32 s56, s53, 0x0
    buffer_load_dwordx4 v6, s[12:15], s56 offen lds
    s_add_u32 s53, s53, 393216
    s_lshl_b32 s56, s62, 2
    s_mov_b32 m0, s57
    s_mov_b64 exec, 1
    buffer_load_dword v45, s[84:87], s56 offen lds
    s_mov_b64 exec, -1
    s_add_u32 s62, s62, 1
    s_add_u32 s78, s78, 1
    s_add_u32 s83, s83, 1
    s_cmp_eq_u32 s83, 7
    s_cselect_b32 s83, 0, s83
    s_sub_i32 s56, s77, 4
    s_lshl_b32 s82, s56, 1
    s_add_i32 s82, s82, 2
    s_add_i32 s89, s56, 11
    s_cmp_ge_i32 s56, 10
    s_cselect_b32 s82, s89, s82
    s_lshl_b32 s89, s56, 1
    s_sub_i32 s89, s89, 1
    s_cmp_ge_i32 s56, 13
    s_cselect_b32 s82, s89, s82
    s_cmp_ge_i32 s88, s82
    s_cbranch_scc1 gate_35_ok
gate_35:
    ds_read_b128 v[36:39], v22 offset:16
    s_waitcnt lgkmcnt(0)
    v_min3_u32 v36, v36, v37, v38
    v_min_u32 v36, v36, v39
    s_nop 0
    v_readfirstlane_b32 s88, v36
    s_add_u32 s63, s63, 1
    s_cmp_ge_i32 s88, s82
    s_cbranch_scc1 gate_35_ok
    s_cmp_gt_u32 s63, 300000
    s_cbranch_scc0 gate_35
gate_35_ok:
    s_waitcnt vmcnt(24)
    s_lshl_b32 s79, s94, 14
    s_add_u32 s79, s79, s65
    s_add_u32 s94, s94, 1
    s_cmp_eq_u32 s94, 4
    s_cselect_b32 s94, 0, s94
    s_add_u32 m0, s79, 0x0
    s_add_u32 s56, s52, 0x0
    buffer_load_dwordx4 v2, s[8:11], s56 offen lds
    s_add_u32 m0, s79, 0x400
    s_add_u32 s56, s52, 0x2800
    buffer_load_dwordx4 v3, s[8:11], s56 offen lds
    s_add_u32 m0, s79, 0x800
    s_add_u32 s56, s52, 0x5000
    buffer_load_dwordx4 v2, s[8:11], s56 offen lds
    s_add_u32 m0, s79, 0xc00
    s_add_u32 s56, s52, 0x7800
    buffer_load_dwordx4 v3, s[8:11], s56 offen lds
    s_add_u32 s62, s62, 1
    s_add_u32 s77, s77, 1
    s_add_u32 s52, s52, 128
    s_sub_i32 s82, s78, 6
    s_add_i32 s56, s82, 3
    s_cmp_ge_i32 s78, 27
    s_cselect_b32 s82, s56, s82
    s_cmp_ge_i32 s88, s82
    s_cbranch_scc1 gate_36_ok
gate_36:
    ds_read_b128 v[36:39], v22 offset:16
    s_waitcnt lgkmcnt(0)
    v_min3_u32 v36, v36, v37, v38
    v_min_u32 v36, v36, v39
    s_nop 0
    v_readfirstlane_b32 s88, v36
    s_add_u32 s63, s63, 1
    s_cmp_ge_i32 s88, s82
    s_cbranch_scc1 gate_36_ok
    s_cmp_gt_u32 s63, 300000
    s_cbranch_scc0 gate_36
gate_36_ok:
    s_mul_i32 s80, s83, 12288
    s_add_u32 s80, s80, s66
    s_add_u32 m0, s80, 0x0
    s_add_u32 s56, s53, 0x0
    buffer_load_dwordx4 v4, s[12:15], s56 offen lds
    s_add_u32 m0, s80, 0x400
    s_add_u32 s56, s53, 0x0
    buffer_load_dwordx4 v5, s[12:15], s56 offen lds
    s_add_u32 m0, s80, 0x800
    s_add_u32 s56, s53, 0x0
    buffer_load_dwordx4 v6, s[12:15], s56 offen lds
    s_add_u32 s53, s53, 393216
    s_add_u32 s62, s62, 1
    s_add_u32 s78, s78, 1
    s_add_u32 s83, s83, 1
    s_cmp_eq_u32 s83, 7
    s_cselect_b32 s83, 0, s83
    s_sub_i32 s82, s78, 6
    s_add_i32 s56, s82, 3
    s_cmp_ge_i32 s78, 27
    s_cselect_b32 s82, s56, s82
    s_cmp_ge_i32 s88, s82
    s_cbranch_scc1 gate_37_ok
gate_37:
    ds_read_b128 v[36:39], v22 offset:16
    s_waitcnt lgkmcnt(0)
    v_min3_u32 v36, v36, v37, v38
    v_min_u32 v36, v36, v39
    s_nop 0
    v_readfirstlane_b32 s88, v36
    s_add_u32 s63, s63, 1
    s_cmp_ge_i32 s88, s82
    s_cbranch_scc1 gate_37_ok
    s_cmp_gt_u32 s63, 300000
    s_cbranch_scc0 gate_37
gate_37_ok:
    s_mul_i32 s80, s83, 12288
    s_add_u32 s80, s80, s66
    s_add_u32 m0, s80, 0x0
    s_add_u32 s56, s53, 0x0
    buffer_load_dwordx4 v4, s[12:15], s56 offen lds
    s_add_u32 m0, s80, 0x400
    s_add_u32 s56, s53, 0x0
    buffer_load_dwordx4 v5, s[12:15], s56 offen lds
    s_add_u32 m0, s80, 0x800
    s_add_u32 s56, s53, 0x0
    buffer_load_dwordx4 v6, s[12:15], s56 offen lds
    s_add_u32 s53, s53, 393216
    s_lshl_b32 s56, s62, 2
    s_mov_b32 m0, s57
    s_mov_b64 exec, 1
    buffer_load_dword v45, s[84:87], s56 offen lds
    s_mov_b64 exec, -1
    s_add_u32 s62, s62, 1
    s_add_u32 s78, s78, 1
    s_add_u32 s83, s83, 1
    s_cmp_eq_u32 s83, 7
    s_cselect_b32 s83, 0, s83
    s_sub_i32 s56, s77, 4
    s_lshl_b32 s82, s56, 1
    s_add_i32 s82, s82, 2
    s_add_i32 s89, s56, 11
    s_cmp_ge_i32 s56, 10
    s_cselect_b32 s82, s89, s82
    s_lshl_b32 s89, s56, 1
    s_sub_i32 s89, s89, 1
    s_cmp_ge_i32 s56, 13
    s_cselect_b32 s82, s89, s82
    s_cmp_ge_i32 s88, s82
    s_cbranch_scc1 gate_38_ok
gate_38:
    ds_read_b128 v[36:39], v22 offset:16
    s_waitcnt lgkmcnt(0)
    v_min3_u32 v36, v36, v37, v38
    v_min_u32 v36, v36, v39
    s_nop 0
    v_readfirstlane_b32 s88, v36
    s_add_u32 s63, s63, 1
    s_cmp_ge_i32 s88, s82
    s_cbranch_scc1 gate_38_ok
    s_cmp_gt_u32 s63, 300000
    s_cbranch_scc0 gate_38
gate_38_ok:
    s_waitcnt vmcnt(24)
    s_lshl_b32 s79, s94, 14
    s_add_u32 s79, s79, s65
    s_add_u32 s94, s94, 1
    s_cmp_eq_u32 s94, 4
    s_cselect_b32 s94, 0, s94
    s_add_u32 m0, s79, 0x0
    s_add_u32 s56, s64, 0x0
    buffer_load_dwordx4 v8, s[16:19], s56 offen lds
    s_add_u32 m0, s79, 0x400
    s_add_u32 s56, s64, 0xc00
    buffer_load_dwordx4 v9, s[16:19], s56 offen lds
    s_add_u32 m0, s79, 0x800
    s_add_u32 s56, s64, 0x1800
    buffer_load_dwordx4 v8, s[16:19], s56 offen lds
    s_add_u32 m0, s79, 0xc00
    s_add_u32 s56, s64, 0x2400
    buffer_load_dwordx4 v9, s[16:19], s56 offen lds
    s_lshl_b32 s56, s62, 2
    s_mov_b32 m0, s57
    s_mov_b64 exec, 1
    buffer_load_dword v45, s[84:87], s56 offen lds
    s_mov_b64 exec, -1
    s_add_u32 s62, s62, 1
    s_add_u32 s77, s77, 1
    s_add_u32 s64, s64, 128
    s_sub_i32 s56, s77, 4
    s_lshl_b32 s82, s56, 1
    s_add_i32 s82, s82, 2
    s_add_i32 s89, s56, 11
    s_cmp_ge_i32 s56, 10
    s_cselect_b32 s82, s89, s82
    s_lshl_b32 s89, s56, 1
    s_sub_i32 s89, s89, 1
    s_cmp_ge_i32 s56, 13
    s_cselect_b32 s82, s89, s82
    s_cmp_ge_i32 s88, s82
    s_cbranch_scc1 gate_39_ok
gate_39:
    ds_read_b128 v[36:39], v22 offset:16
    s_waitcnt lgkmcnt(0)
    v_min3_u32 v36, v36, v37, v38
    v_min_u32 v36, v36, v39
    s_nop 0
    v_readfirstlane_b32 s88, v36
    s_add_u32 s63, s63, 1
    s_cmp_ge_i32 s88, s82
    s_cbranch_scc1 gate_39_ok
    s_cmp_gt_u32 s63, 300000
    s_cbranch_scc0 gate_39
gate_39_ok:
    s_waitcnt vmcnt(24)
    s_lshl_b32 s79, s94, 14
    s_add_u32 s79, s79, s65
    s_add_u32 s94, s94, 1
    s_cmp_eq_u32 s94, 4
    s_cselect_b32 s94, 0, s94
    s_add_u32 m0, s79, 0x0
    s_add_u32 s56, s64, 0x0
    buffer_load_dwordx4 v8, s[16:19], s56 offen lds
    s_add_u32 m0, s79, 0x400
    s_add_u32 s56, s64, 0xc00
    buffer_load_dwordx4 v9, s[16:19], s56 offen lds
    s_add_u32 m0, s79, 0x800
    s_add_u32 s56, s64, 0x1800
    buffer_load_dwordx4 v8, s[16:19], s56 offen lds
    s_add_u32 m0, s79, 0xc00
    s_add_u32 s56, s64, 0x2400
    buffer_load_dwordx4 v9, s[16:19], s56 offen lds
    s_lshl_b32 s56, s62, 2
    s_mov_b32 m0, s57
    s_mov_b64 exec, 1
    buffer_load_dword v45, s[84:87], s56 offen lds
    s_mov_b64 exec, -1
    s_add_u32 s62, s62, 1
    s_add_u32 s77, s77, 1
    s_add_u32 s64, s64, 128
    s_sub_i32 s56, s77, 4
    s_lshl_b32 s82, s56, 1
    s_add_i32 s82, s82, 2
    s_add_i32 s89, s56, 11
    s_cmp_ge_i32 s56, 10
    s_cselect_b32 s82, s89, s82
    s_lshl_b32 s89, s56, 1
    s_sub_i32 s89, s89, 1
    s_cmp_ge_i32 s56, 13
    s_cselect_b32 s82, s89, s82
    s_cmp_ge_i32 s88, s82
    s_cbranch_scc1 gate_40_ok
gate_40:
    ds_read_b128 v[36:39], v22 offset:16
    s_waitcnt lgkmcnt(0)
    v_min3_u32 v36, v36, v37, v38
    v_min_u32 v36, v36, v39
    s_nop 0
    v_readfirstlane_b32 s88, v36
    s_add_u32 s63, s63, 1
    s_cmp_ge_i32 s88, s82
    s_cbranch_scc1 gate_40_ok
    s_cmp_gt_u32 s63, 300000
    s_cbranch_scc0 gate_40
gate_40_ok:
    s_waitcnt vmcnt(24)
    s_lshl_b32 s79, s94, 14
    s_add_u32 s79, s79, s65
    s_add_u32 s94, s94, 1
    s_cmp_eq_u32 s94, 4
    s_cselect_b32 s94, 0, s94
    s_add_u32 m0, s79, 0x0
    s_add_u32 s56, s64, 0x0
    buffer_load_dwordx4 v8, s[16:19], s56 offen lds
    s_add_u32 m0, s79, 0x400
    s_add_u32 s56, s64, 0xc00
    buffer_load_dwordx4 v9, s[16:19], s56 offen lds
    s_add_u32 m0, s79, 0x800
    s_add_u32 s56, s64, 0x1800
    buffer_load_dwordx4 v8, s[16:19], s56 offen lds
    s_add_u32 m0, s79, 0xc00
    s_add_u32 s56, s64, 0x2400
    buffer_load_dwordx4 v9, s[16:19], s56 offen lds
    s_lshl_b32 s56, s62, 2
    s_mov_b32 m0, s57
    s_mov_b64 exec, 1
    buffer_load_dword v45, s[84:87], s56 offen lds
    s_mov_b64 exec, -1
    s_add_u32 s62, s62, 1
    s_add_u32 s77, s77, 1
    s_add_u32 s64, s64, 128
    s_mul_i32 s56, s71, 1
    s_add_u32 s56, s56, s70
    s_mul_i32 s56, s71, 5
    s_add_u32 s56, s56, s70
nb_41:
    s_sub_i32 s56, s77, 4
    s_lshl_b32 s82, s56, 1
    s_add_i32 s82, s82, 2
    s_add_i32 s89, s56, 11
    s_cmp_ge_i32 s56, 10
    s_cselect_b32 s82, s89, s82
    s_lshl_b32 s89, s56, 1
    s_sub_i32 s89, s89, 1
    s_cmp_ge_i32 s56, 13
    s_cselect_b32 s82, s89, s82
    s_cmp_ge_i32 s88, s82
    s_cbranch_scc1 gate_42_ok
gate_42:
    ds_read_b128 v[36:39], v22 offset:16
    s_waitcnt lgkmcnt(0)
    v_min3_u32 v36, v36, v37, v38
    v_min_u32 v36, v36, v39
    s_nop 0
    v_readfirstlane_b32 s88, v36
    s_add_u32 s63, s63, 1
    s_cmp_ge_i32 s88, s82
    s_cbranch_scc1 gate_42_ok
    s_cmp_gt_u32 s63, 300000
    s_cbranch_scc0 gate_42
gate_42_ok:
    s_waitcnt vmcnt(24)
    s_lshl_b32 s79, s94, 14
    s_add_u32 s79, s79, s65
    s_add_u32 s94, s94, 1
    s_cmp_eq_u32 s94, 4
    s_cselect_b32 s94, 0, s94
    s_add_u32 m0, s79, 0x0
    s_add_u32 s56, s54, 0x0
    buffer_load_dwordx4 v8, s[20:23], s56 offen lds
    s_add_u32 m0, s79, 0x400
    s_add_u32 s56, s54, 0xc00
    buffer_load_dwordx4 v9, s[20:23], s56 offen lds
    s_add_u32 m0, s79, 0x800
    s_add_u32 s56, s54, 0x1800
    buffer_load_dwordx4 v8, s[20:23], s56 offen lds
    s_add_u32 m0, s79, 0xc00
    s_add_u32 s56, s54, 0x2400
    buffer_load_dwordx4 v9, s[20:23], s56 offen lds
    s_add_u32 s62, s62, 1
    s_add_u32 s77, s77, 1
    s_add_u32 s54, s54, 128
    s_sub_i32 s82, s78, 6
    s_add_i32 s56, s82, 3
    s_cmp_ge_i32 s78, 27
    s_cselect_b32 s82, s56, s82
    s_cmp_ge_i32 s88, s82
    s_cbranch_scc1 gate_43_ok
gate_43:
    ds_read_b128 v[36:39], v22 offset:16
    s_waitcnt lgkmcnt(0)
    v_min3_u32 v36, v36, v37, v38
    v_min_u32 v36, v36, v39
    s_nop 0
    v_readfirstlane_b32 s88, v36
    s_add_u32 s63, s63, 1
    s_cmp_ge_i32 s88, s82
    s_cbranch_scc1 gate_43_ok
    s_cmp_gt_u32 s63, 300000
    s_cbranch_scc0 gate_43
gate_43_ok:
    s_mul_i32 s80, s83, 12288
    s_add_u32 s80, s80, s67
    s_add_u32 m0, s80, 0x0
    s_add_u32 s56, s55, 0x0
    buffer_load_dwordx4 v10, s[24:27], s56 offen lds
    s_add_u32 m0, s80, 0x400
    s_add_u32 s56, s55, 0x0
    buffer_load_dwordx4 v11, s[24:27], s56 offen lds
    s_cmp_ge_u32 s58, 2
    s_cbranch_scc1 w3_44
    s_add_u32 m0, s80, 0x800
    s_add_u32 s56, s55, 0x0
    buffer_load_dwordx4 v12, s[24:27], s56 offen lds
w3_44:
    s_add_u32 s55, s55, 40960
    s_add_u32 s62, s62, 1
    s_add_u32 s78, s78, 1
    s_add_u32 s83, s83, 1
    s_cmp_eq_u32 s83, 7
    s_cselect_b32 s83, 0, s83
    s_sub_i32 s82, s78, 6
    s_add_i32 s56, s82, 3
    s_cmp_ge_i32 s78, 27
    s_cselect_b32 s82, s56, s82
    s_cmp_ge_i32 s88, s82
    s_cbranch_scc1 gate_45_ok
gate_45:
    ds_read_b128 v[36:39], v22 offset:16
    s_waitcnt lgkmcnt(0)
    v_min3_u32 v36, v36, v37, v38
    v_min_u32 v36, v36, v39
    s_nop 0
    v_readfirstlane_b32 s88, v36
    s_add_u32 s63, s63, 1
    s_cmp_ge_i32 s88, s82
    s_cbranch_scc1 gate_45_ok
    s_cmp_gt_u32 s63, 300000
    s_cbranch_scc0 gate_45
gate_45_ok:
    s_mul_i32 s80, s83, 12288
    s_add_u32 s80, s80, s67
    s_add_u32 m0, s80, 0x0
    s_add_u32 s56, s55, 0x0
    buffer_load_dwordx4 v10, s[24:27], s56 offen lds
    s_add_u32 m0, s80, 0x400
    s_add_u32 s56, s55, 0x0
    buffer_load_dwordx4 v11, s[24:27], s56 offen lds
    s_cmp_ge_u32 s58, 2
    s_cbranch_scc1 w3_46
    s_add_u32 m0, s80, 0x800
    s_add_u32 s56, s55, 0x0
    buffer_load_dwordx4 v12, s[24:27], s56 offen lds
w3_46:
    s_add_u32 s55, s55, 40960
    s_lshl_b32 s56, s62, 2
    s_mov_b32 m0, s57
    s_mov_b64 exec, 1
    buffer_load_dword v45, s[84:87], s56 offen lds
    s_mov_b64 exec, -1
    s_add_u32 s62, s62, 1
    s_add_u32 s78, s78, 1
    s_add_u32 s83, s83, 1
    s_cmp_eq_u32 s83, 7
    s_cselect_b32 s83, 0, s83
    s_sub_i32 s56, s77, 4
    s_lshl_b32 s82, s56, 1
    s_add_i32 s82, s82, 2
    s_add_i32 s89, s56, 11
    s_cmp_ge_i32 s56, 10
    s_cselect_b32 s82, s89, s82
    s_lshl_b32 s89, s56, 1
    s_sub_i32 s89, s89, 1
    s_cmp_ge_i32 s56, 13
    s_cselect_b32 s82, s89, s82
    s_cmp_ge_i32 s88, s82
    s_cbranch_scc1 gate_47_ok
gate_47:
    ds_read_b128 v[36:39], v22 offset:16
    s_waitcnt lgkmcnt(0)
    v_min3_u32 v36, v36, v37, v38
    v_min_u32 v36, v36, v39
    s_nop 0
    v_readfirstlane_b32 s88, v36
    s_add_u32 s63, s63, 1
    s_cmp_ge_i32 s88, s82
    s_cbranch_scc1 gate_47_ok
    s_cmp_gt_u32 s63, 300000
    s_cbranch_scc0 gate_47
gate_47_ok:
    s_waitcnt vmcnt(24)
    s_lshl_b32 s79, s94, 14
    s_add_u32 s79, s79, s65
    s_add_u32 s94, s94, 1
    s_cmp_eq_u32 s94, 4
    s_cselect_b32 s94, 0, s94
    s_add_u32 m0, s79, 0x0
    s_add_u32 s56, s54, 0x0
    buffer_load_dwordx4 v8, s[20:23], s56 offen lds
    s_add_u32 m0, s79, 0x400
    s_add_u32 s56, s54, 0xc00
    buffer_load_dwordx4 v9, s[20:23], s56 offen lds
    s_add_u32 m0, s79, 0x800
    s_add_u32 s56, s54, 0x1800
    buffer_load_dwordx4 v8, s[20:23], s56 offen lds
    s_add_u32 m0, s79, 0xc00
    s_add_u32 s56, s54, 0x2400
    buffer_load_dwordx4 v9, s[20:23], s56 offen lds
    s_add_u32 s62, s62, 1
    s_add_u32 s77, s77, 1
    s_add_u32 s54, s54, 128
    s_sub_i32 s82, s78, 6
    s_add_i32 s56, s82, 3
    s_cmp_ge_i32 s78, 27
    s_cselect_b32 s82, s56, s82
    s_cmp_ge_i32 s88, s82
    s_cbranch_scc1 gate_48_ok
gate_48:
    ds_read_b128 v[36:39], v22 offset:16
    s_waitcnt lgkmcnt(0)
    v_min3_u32 v36, v36, v37, v38
    v_min_u32 v36, v36, v39
    s_nop 0
    v_readfirstlane_b32 s88, v36
    s_add_u32 s63, s63, 1
    s_cmp_ge_i32 s88, s82
    s_cbranch_scc1 gate_48_ok
    s_cmp_gt_u32 s63, 300000
    s_cbranch_scc0 gate_48
gate_48_ok:
    s_mul_i32 s80, s83, 12288
    s_add_u32 s80, s80, s67
    s_add_u32 m0, s80, 0x0
    s_add_u32 s56, s55, 0x0
    buffer_load_dwordx4 v10, s[24:27], s56 offen lds
    s_add_u32 m0, s80, 0x400
    s_add_u32 s56, s55, 0x0
    buffer_load_dwordx4 v11, s[24:27], s56 offen lds
    s_cmp_ge_u32 s58, 2
    s_cbranch_scc1 w3_49
    s_add_u32 m0, s80, 0x800
    s_add_u32 s56, s55, 0x0
    buffer_load_dwordx4 v12, s[24:27], s56 offen lds
w3_49:
    s_add_u32 s55, s55, 40960
    s_add_u32 s62, s62, 1
    s_add_u32 s78, s78, 1
    s_add_u32 s83, s83, 1
    s_cmp_eq_u32 s83, 7
    s_cselect_b32 s83, 0, s83
    s_sub_i32 s82, s78, 6
    s_add_i32 s56, s82, 3
    s_cmp_ge_i32 s78, 27
    s_cselect_b32 s82, s56, s82
    s_cmp_ge_i32 s88, s82
    s_cbranch_scc1 gate_50_ok
gate_50:
    ds_read_b128 v[36:39], v22 offset:16
    s_waitcnt lgkmcnt(0)
    v_min3_u32 v36, v36, v37, v38
    v_min_u32 v36, v36, v39
    s_nop 0
    v_readfirstlane_b32 s88, v36
    s_add_u32 s63, s63, 1
    s_cmp_ge_i32 s88, s82
    s_cbranch_scc1 gate_50_ok
    s_cmp_gt_u32 s63, 300000
    s_cbranch_scc0 gate_50
gate_50_ok:
    s_mul_i32 s80, s83, 12288
    s_add_u32 s80, s80, s67
    s_add_u32 m0, s80, 0x0
    s_add_u32 s56, s55, 0x0
    buffer_load_dwordx4 v10, s[24:27], s56 offen lds
    s_add_u32 m0, s80, 0x400
    s_add_u32 s56, s55, 0x0
    buffer_load_dwordx4 v11, s[24:27], s56 offen lds
    s_cmp_ge_u32 s58, 2
    s_cbranch_scc1 w3_51
    s_add_u32 m0, s80, 0x800
    s_add_u32 s56, s55, 0x0
    buffer_load_dwordx4 v12, s[24:27], s56 offen lds
w3_51:
    s_add_u32 s55, s55, 40960
    s_lshl_b32 s56, s62, 2
    s_mov_b32 m0, s57
    s_mov_b64 exec, 1
    buffer_load_dword v45, s[84:87], s56 offen lds
    s_mov_b64 exec, -1
    s_add_u32 s62, s62, 1
    s_add_u32 s78, s78, 1
    s_add_u32 s83, s83, 1
    s_cmp_eq_u32 s83, 7
    s_cselect_b32 s83, 0, s83
    s_sub_i32 s56, s77, 4
    s_lshl_b32 s82, s56, 1
    s_add_i32 s82, s82, 2
    s_add_i32 s89, s56, 11
    s_cmp_ge_i32 s56, 10
    s_cselect_b32 s82, s89, s82
    s_lshl_b32 s89, s56, 1
    s_sub_i32 s89, s89, 1
    s_cmp_ge_i32 s56, 13
    s_cselect_b32 s82, s89, s82
    s_cmp_ge_i32 s88, s82
    s_cbranch_scc1 gate_52_ok
gate_52:
    ds_read_b128 v[36:39], v22 offset:16
    s_waitcnt lgkmcnt(0)
    v_min3_u32 v36, v36, v37, v38
    v_min_u32 v36, v36, v39
    s_nop 0
    v_readfirstlane_b32 s88, v36
    s_add_u32 s63, s63, 1
    s_cmp_ge_i32 s88, s82
    s_cbranch_scc1 gate_52_ok
    s_cmp_gt_u32 s63, 300000
    s_cbranch_scc0 gate_52
gate_52_ok:
    s_waitcnt vmcnt(24)
    s_lshl_b32 s79, s94, 14
    s_add_u32 s79, s79, s65
    s_add_u32 s94, s94, 1
    s_cmp_eq_u32 s94, 4
    s_cselect_b32 s94, 0, s94
    s_add_u32 m0, s79, 0x0
    s_add_u32 s56, s54, 0x0
    buffer_load_dwordx4 v8, s[20:23], s56 offen lds
    s_add_u32 m0, s79, 0x400
    s_add_u32 s56, s54, 0xc00
    buffer_load_dwordx4 v9, s[20:23], s56 offen lds
    s_add_u32 m0, s79, 0x800
    s_add_u32 s56, s54, 0x1800
    buffer_load_dwordx4 v8, s[20:23], s56 offen lds
    s_add_u32 m0, s79, 0xc00
    s_add_u32 s56, s54, 0x2400
    buffer_load_dwordx4 v9, s[20:23], s56 offen lds
    s_add_u32 s62, s62, 1
    s_add_u32 s77, s77, 1
    s_add_u32 s54, s54, 12032
    s_sub_i32 s82, s78, 6
    s_add_i32 s56, s82, 3
    s_cmp_ge_i32 s78, 27
    s_cselect_b32 s82, s56, s82
    s_cmp_ge_i32 s88, s82
    s_cbranch_scc1 gate_53_ok
gate_53:
    ds_read_b128 v[36:39], v22 offset:16
    s_waitcnt lgkmcnt(0)
    v_min3_u32 v36, v36, v37, v38
    v_min_u32 v36, v36, v39
    s_nop 0
    v_readfirstlane_b32 s88, v36
    s_add_u32 s63, s63, 1
    s_cmp_ge_i32 s88, s82
    s_cbranch_scc1 gate_53_ok
    s_cmp_gt_u32 s63, 300000
    s_cbranch_scc0 gate_53
gate_53_ok:
    s_mul_i32 s80, s83, 12288
    s_add_u32 s80, s80, s67
    s_add_u32 m0, s80, 0x0
    s_add_u32 s56, s55, 0x0
    buffer_load_dwordx4 v10, s[24:27], s56 offen lds
    s_add_u32 m0, s80, 0x400
    s_add_u32 s56, s55, 0x0
    buffer_load_dwordx4 v11, s[24:27], s56 offen lds
    s_cmp_ge_u32 s58, 2
    s_cbranch_scc1 w3_54
    s_add_u32 m0, s80, 0x800
    s_add_u32 s56, s55, 0x0
    buffer_load_dwordx4 v12, s[24:27], s56 offen lds
w3_54:
    s_add_u32 s55, s55, 40960
    s_add_u32 s62, s62, 1
    s_add_u32 s78, s78, 1
    s_add_u32 s83, s83, 1
    s_cmp_eq_u32 s83, 7
    s_cselect_b32 s83, 0, s83
    s_sub_i32 s82, s78, 6
    s_add_i32 s56, s82, 3
    s_cmp_ge_i32 s78, 27
    s_cselect_b32 s82, s56, s82
    s_cmp_ge_i32 s88, s82
    s_cbranch_scc1 gate_55_ok
gate_55:
    ds_read_b128 v[36:39], v22 offset:16
    s_waitcnt lgkmcnt(0)
    v_min3_u32 v36, v36, v37, v38
    v_min_u32 v36, v36, v39
    s_nop 0
    v_readfirstlane_b32 s88, v36
    s_add_u32 s63, s63, 1
    s_cmp_ge_i32 s88, s82
    s_cbranch_scc1 gate_55_ok
    s_cmp_gt_u32 s63, 300000
    s_cbranch_scc0 gate_55
gate_55_ok:
    s_mul_i32 s80, s83, 12288
    s_add_u32 s80, s80, s67
    s_add_u32 m0, s80, 0x0
    s_add_u32 s56, s55, 0x0
    buffer_load_dwordx4 v10, s[24:27], s56 offen lds
    s_add_u32 m0, s80, 0x400
    s_add_u32 s56, s55, 0x0
    buffer_load_dwordx4 v11, s[24:27], s56 offen lds
    s_cmp_ge_u32 s58, 2
    s_cbranch_scc1 w3_56
    s_add_u32 m0, s80, 0x800
    s_add_u32 s56, s55, 0x0
    buffer_load_dwordx4 v12, s[24:27], s56 offen lds
w3_56:
    s_add_u32 s55, s55, 40960
    s_lshl_b32 s56, s62, 2
    s_mov_b32 m0, s57
    s_mov_b64 exec, 1
    buffer_load_dword v45, s[84:87], s56 offen lds
    s_mov_b64 exec, -1
    s_add_u32 s62, s62, 1
    s_add_u32 s78, s78, 1
    s_add_u32 s83, s83, 1
    s_cmp_eq_u32 s83, 7
    s_cselect_b32 s83, 0, s83
    s_mul_i32 s56, s71, 2
    s_add_u32 s56, s56, s70
    s_mul_i32 s56, s71, 6
    s_add_u32 s56, s56, s70
nb_57:
    s_sub_i32 s56, s77, 4
    s_lshl_b32 s82, s56, 1
    s_add_i32 s82, s82, 2
    s_add_i32 s89, s56, 11
    s_cmp_ge_i32 s56, 10
    s_cselect_b32 s82, s89, s82
    s_lshl_b32 s89, s56, 1
    s_sub_i32 s89, s89, 1
    s_cmp_ge_i32 s56, 13
    s_cselect_b32 s82, s89, s82
    s_cmp_ge_i32 s88, s82
    s_cbranch_scc1 gate_58_ok
gate_58:
    ds_read_b128 v[36:39], v22 offset:16
    s_waitcnt lgkmcnt(0)
    v_min3_u32 v36, v36, v37, v38
    v_min_u32 v36, v36, v39
    s_nop 0
    v_readfirstlane_b32 s88, v36
    s_add_u32 s63, s63, 1
    s_cmp_ge_i32 s88, s82
    s_cbranch_scc1 gate_58_ok
    s_cmp_gt_u32 s63, 300000
    s_cbranch_scc0 gate_58
gate_58_ok:
    s_waitcnt vmcnt(24)
    s_lshl_b32 s79, s94, 14
    s_add_u32 s79, s79, s65
    s_add_u32 s94, s94, 1
    s_cmp_eq_u32 s94, 4
    s_cselect_b32 s94, 0, s94
    s_add_u32 m0, s79, 0x0
    s_add_u32 s56, s54, 0x0
    buffer_load_dwordx4 v8, s[20:23], s56 offen lds
    s_add_u32 m0, s79, 0x400
    s_add_u32 s56, s54, 0xc00
    buffer_load_dwordx4 v9, s[20:23], s56 offen lds
    s_add_u32 m0, s79, 0x800
    s_add_u32 s56, s54, 0x1800
    buffer_load_dwordx4 v8, s[20:23], s56 offen lds
    s_add_u32 m0, s79, 0xc00
    s_add_u32 s56, s54, 0x2400
    buffer_load_dwordx4 v9, s[20:23], s56 offen lds
    s_add_u32 s62, s62, 1
    s_add_u32 s77, s77, 1
    s_add_u32 s54, s54, 128
    s_sub_i32 s82, s78, 6
    s_add_i32 s56, s82, 3
    s_cmp_ge_i32 s78, 27
    s_cselect_b32 s82, s56, s82
    s_cmp_ge_i32 s88, s82
    s_cbranch_scc1 gate_59_ok
gate_59:
    ds_read_b128 v[36:39], v22 offset:16
    s_waitcnt lgkmcnt(0)
    v_min3_u32 v36, v36, v37, v38
    v_min_u32 v36, v36, v39
    s_nop 0
    v_readfirstlane_b32 s88, v36
    s_add_u32 s63, s63, 1
    s_cmp_ge_i32 s88, s82
    s_cbranch_scc1 gate_59_ok
    s_cmp_gt_u32 s63, 300000
    s_cbranch_scc0 gate_59
gate_59_ok:
    s_mul_i32 s80, s83, 12288
    s_add_u32 s80, s80, s67
    s_add_u32 m0, s80, 0x0
    s_add_u32 s56, s55, 0x0
    buffer_load_dwordx4 v10, s[24:27], s56 offen lds
    s_add_u32 m0, s80, 0x400
    s_add_u32 s56, s55, 0x0
    buffer_load_dwordx4 v11, s[24:27], s56 offen lds
    s_cmp_ge_u32 s58, 2
    s_cbranch_scc1 w3_60
    s_add_u32 m0, s80, 0x800
    s_add_u32 s56, s55, 0x0
    buffer_load_dwordx4 v12, s[24:27], s56 offen lds
w3_60:
    s_add_u32 s55, s55, 40960
    s_add_u32 s62, s62, 1
    s_add_u32 s78, s78, 1
    s_add_u32 s83, s83, 1
    s_cmp_eq_u32 s83, 7
    s_cselect_b32 s83, 0, s83
    s_sub_i32 s82, s78, 6
    s_add_i32 s56, s82, 3
    s_cmp_ge_i32 s78, 27
    s_cselect_b32 s82, s56, s82
    s_cmp_ge_i32 s88, s82
    s_cbranch_scc1 gate_61_ok
gate_61:
    ds_read_b128 v[36:39], v22 offset:16
    s_waitcnt lgkmcnt(0)
    v_min3_u32 v36, v36, v37, v38
    v_min_u32 v36, v36, v39
    s_nop 0
    v_readfirstlane_b32 s88, v36
    s_add_u32 s63, s63, 1
    s_cmp_ge_i32 s88, s82
    s_cbranch_scc1 gate_61_ok
    s_cmp_gt_u32 s63, 300000
    s_cbranch_scc0 gate_61
gate_61_ok:
    s_mul_i32 s80, s83, 12288
    s_add_u32 s80, s80, s67
    s_add_u32 m0, s80, 0x0
    s_add_u32 s56, s55, 0x0
    buffer_load_dwordx4 v10, s[24:27], s56 offen lds
    s_add_u32 m0, s80, 0x400
    s_add_u32 s56, s55, 0x0
    buffer_load_dwordx4 v11, s[24:27], s56 offen lds
    s_cmp_ge_u32 s58, 2
    s_cbranch_scc1 w3_62
    s_add_u32 m0, s80, 0x800
    s_add_u32 s56, s55, 0x0
    buffer_load_dwordx4 v12, s[24:27], s56 offen lds
w3_62:
    s_add_u32 s55, s55, 40960
    s_lshl_b32 s56, s62, 2
    s_mov_b32 m0, s57
    s_mov_b64 exec, 1
    buffer_load_dword v45, s[84:87], s56 offen lds
    s_mov_b64 exec, -1
    s_add_u32 s62, s62, 1
    s_add_u32 s78, s78, 1
    s_add_u32 s83, s83, 1
    s_cmp_eq_u32 s83, 7
    s_cselect_b32 s83, 0, s83
    s_sub_i32 s56, s77, 4
    s_lshl_b32 s82, s56, 1
    s_add_i32 s82, s82, 2
    s_add_i32 s89, s56, 11
    s_cmp_ge_i32 s56, 10
    s_cselect_b32 s82, s89, s82
    s_lshl_b32 s89, s56, 1
    s_sub_i32 s89, s89, 1
    s_cmp_ge_i32 s56, 13
    s_cselect_b32 s82, s89, s82
    s_cmp_ge_i32 s88, s82
    s_cbranch_scc1 gate_63_ok
gate_63:
    ds_read_b128 v[36:39], v22 offset:16
    s_waitcnt lgkmcnt(0)
    v_min3_u32 v36, v36, v37, v38
    v_min_u32 v36, v36, v39
    s_nop 0
    v_readfirstlane_b32 s88, v36
    s_add_u32 s63, s63, 1
    s_cmp_ge_i32 s88, s82
    s_cbranch_scc1 gate_63_ok
    s_cmp_gt_u32 s63, 300000
    s_cbranch_scc0 gate_63
gate_63_ok:
    s_waitcnt vmcnt(24)
    s_lshl_b32 s79, s94, 14
    s_add_u32 s79, s79, s65
    s_add_u32 s94, s94, 1
    s_cmp_eq_u32 s94, 4
    s_cselect_b32 s94, 0, s94
    s_add_u32 m0, s79, 0x0
    s_add_u32 s56, s54, 0x0
    buffer_load_dwordx4 v8, s[20:23], s56 offen lds
    s_add_u32 m0, s79, 0x400
    s_add_u32 s56, s54, 0xc00
    buffer_load_dwordx4 v9, s[20:23], s56 offen lds
    s_add_u32 m0, s79, 0x800
    s_add_u32 s56, s54, 0x1800
    buffer_load_dwordx4 v8, s[20:23], s56 offen lds
    s_add_u32 m0, s79, 0xc00
    s_add_u32 s56, s54, 0x2400
    buffer_load_dwordx4 v9, s[20:23], s56 offen lds
    s_add_u32 s62, s62, 1
    s_add_u32 s77, s77, 1
    s_add_u32 s54, s54, 128
    s_sub_i32 s82, s78, 6
    s_add_i32 s56, s82, 3
    s_cmp_ge_i32 s78, 27
    s_cselect_b32 s82, s56, s82
    s_cmp_ge_i32 s88, s82
    s_cbranch_scc1 gate_64_ok
gate_64:
    ds_read_b128 v[36:39], v22 offset:16
    s_waitcnt lgkmcnt(0)
    v_min3_u32 v36, v36, v37, v38
    v_min_u32 v36, v36, v39
    s_nop 0
    v_readfirstlane_b32 s88, v36
    s_add_u32 s63, s63, 1
    s_cmp_ge_i32 s88, s82
    s_cbranch_scc1 gate_64_ok
    s_cmp_gt_u32 s63, 300000
    s_cbranch_scc0 gate_64
gate_64_ok:
    s_mul_i32 s80, s83, 12288
    s_add_u32 s80, s80, s67
    s_add_u32 m0, s80, 0x0
    s_add_u32 s56, s55, 0x0
    buffer_load_dwordx4 v10, s[24:27], s56 offen lds
    s_add_u32 m0, s80, 0x400
    s_add_u32 s56, s55, 0x0
    buffer_load_dwordx4 v11, s[24:27], s56 offen lds
    s_cmp_ge_u32 s58, 2
    s_cbranch_scc1 w3_65
    s_add_u32 m0, s80, 0x800
    s_add_u32 s56, s55, 0x0
    buffer_load_dwordx4 v12, s[24:27], s56 offen lds
w3_65:
    s_add_u32 s55, s55, 40960
    s_add_u32 s62, s62, 1
    s_add_u32 s78, s78, 1
    s_add_u32 s83, s83, 1
    s_cmp_eq_u32 s83, 7
    s_cselect_b32 s83, 0, s83
    s_sub_i32 s82, s78, 6
    s_add_i32 s56, s82, 3
    s_cmp_ge_i32 s78, 27
    s_cselect_b32 s82, s56, s82
    s_cmp_ge_i32 s88, s82
    s_cbranch_scc1 gate_66_ok
gate_66:
    ds_read_b128 v[36:39], v22 offset:16
    s_waitcnt lgkmcnt(0)
    v_min3_u32 v36, v36, v37, v38
    v_min_u32 v36, v36, v39
    s_nop 0
    v_readfirstlane_b32 s88, v36
    s_add_u32 s63, s63, 1
    s_cmp_ge_i32 s88, s82
    s_cbranch_scc1 gate_66_ok
    s_cmp_gt_u32 s63, 300000
    s_cbranch_scc0 gate_66
gate_66_ok:
    s_mul_i32 s80, s83, 12288
    s_add_u32 s80, s80, s67
    s_add_u32 m0, s80, 0x0
    s_add_u32 s56, s55, 0x0
    buffer_load_dwordx4 v10, s[24:27], s56 offen lds
    s_add_u32 m0, s80, 0x400
    s_add_u32 s56, s55, 0x0
    buffer_load_dwordx4 v11, s[24:27], s56 offen lds
    s_cmp_ge_u32 s58, 2
    s_cbranch_scc1 w3_67
    s_add_u32 m0, s80, 0x800
    s_add_u32 s56, s55, 0x0
    buffer_load_dwordx4 v12, s[24:27], s56 offen lds
w3_67:
    s_add_u32 s55, s55, 40960
    s_lshl_b32 s56, s62, 2
    s_mov_b32 m0, s57
    s_mov_b64 exec, 1
    buffer_load_dword v45, s[84:87], s56 offen lds
    s_mov_b64 exec, -1
    s_add_u32 s62, s62, 1
    s_add_u32 s78, s78, 1
    s_add_u32 s83, s83, 1
    s_cmp_eq_u32 s83, 7
    s_cselect_b32 s83, 0, s83
    s_sub_i32 s56, s77, 4
    s_lshl_b32 s82, s56, 1
    s_add_i32 s82, s82, 2
    s_add_i32 s89, s56, 11
    s_cmp_ge_i32 s56, 10
    s_cselect_b32 s82, s89, s82
    s_lshl_b32 s89, s56, 1
    s_sub_i32 s89, s89, 1
    s_cmp_ge_i32 s56, 13
    s_cselect_b32 s82, s89, s82
    s_cmp_ge_i32 s88, s82
    s_cbranch_scc1 gate_68_ok
gate_68:
    ds_read_b128 v[36:39], v22 offset:16
    s_waitcnt lgkmcnt(0)
    v_min3_u32 v36, v36, v37, v38
    v_min_u32 v36, v36, v39
    s_nop 0
    v_readfirstlane_b32 s88, v36
    s_add_u32 s63, s63, 1
    s_cmp_ge_i32 s88, s82
    s_cbranch_scc1 gate_68_ok
    s_cmp_gt_u32 s63, 300000
    s_cbranch_scc0 gate_68
gate_68_ok:
    s_waitcnt vmcnt(24)
    s_lshl_b32 s79, s94, 14
    s_add_u32 s79, s79, s65
    s_add_u32 s94, s94, 1
    s_cmp_eq_u32 s94, 4
    s_cselect_b32 s94, 0, s94
    s_add_u32 m0, s79, 0x0
    s_add_u32 s56, s54, 0x0
    buffer_load_dwordx4 v8, s[20:23], s56 offen lds
    s_add_u32 m0, s79, 0x400
    s_add_u32 s56, s54, 0xc00
    buffer_load_dwordx4 v9, s[20:23], s56 offen lds
    s_add_u32 m0, s79, 0x800
    s_add_u32 s56, s54, 0x1800
    buffer_load_dwordx4 v8, s[20:23], s56 offen lds
    s_add_u32 m0, s79, 0xc00
    s_add_u32 s56, s54, 0x2400
    buffer_load_dwordx4 v9, s[20:23], s56 offen lds
    s_add_u32 s62, s62, 1
    s_add_u32 s77, s77, 1
    s_add_u32 s54, s54, 12032
    s_sub_i32 s82, s78, 6
    s_add_i32 s56, s82, 3
    s_cmp_ge_i32 s78, 27
    s_cselect_b32 s82, s56, s82
    s_cmp_ge_i32 s88, s82
    s_cbranch_scc1 gate_69_ok
gate_69:
    ds_read_b128 v[36:39], v22 offset:16
    s_waitcnt lgkmcnt(0)
    v_min3_u32 v36, v36, v37, v38
    v_min_u32 v36, v36, v39
    s_nop 0
    v_readfirstlane_b32 s88, v36
    s_add_u32 s63, s63, 1
    s_cmp_ge_i32 s88, s82
    s_cbranch_scc1 gate_69_ok
    s_cmp_gt_u32 s63, 300000
    s_cbranch_scc0 gate_69
gate_69_ok:
    s_mul_i32 s80, s83, 12288
    s_add_u32 s80, s80, s67
    s_add_u32 m0, s80, 0x0
    s_add_u32 s56, s55, 0x0
    buffer_load_dwordx4 v10, s[24:27], s56 offen lds
    s_add_u32 m0, s80, 0x400
    s_add_u32 s56, s55, 0x0
    buffer_load_dwordx4 v11, s[24:27], s56 offen lds
    s_cmp_ge_u32 s58, 2
    s_cbranch_scc1 w3_70
    s_add_u32 m0, s80, 0x800
    s_add_u32 s56, s55, 0x0
    buffer_load_dwordx4 v12, s[24:27], s56 offen lds
w3_70:
    s_add_u32 s55, s55, 40960
    s_add_u32 s62, s62, 1
    s_add_u32 s78, s78, 1
    s_add_u32 s83, s83, 1
    s_cmp_eq_u32 s83, 7
    s_cselect_b32 s83, 0, s83
    s_sub_i32 s82, s78, 6
    s_add_i32 s56, s82, 3
    s_cmp_ge_i32 s78, 27
    s_cselect_b32 s82, s56, s82
    s_cmp_ge_i32 s88, s82
    s_cbranch_scc1 gate_71_ok
gate_71:
    ds_read_b128 v[36:39], v22 offset:16
    s_waitcnt lgkmcnt(0)
    v_min3_u32 v36, v36, v37, v38
    v_min_u32 v36, v36, v39
    s_nop 0
    v_readfirstlane_b32 s88, v36
    s_add_u32 s63, s63, 1
    s_cmp_ge_i32 s88, s82
    s_cbranch_scc1 gate_71_ok
    s_cmp_gt_u32 s63, 300000
    s_cbranch_scc0 gate_71
gate_71_ok:
    s_mul_i32 s80, s83, 12288
    s_add_u32 s80, s80, s67
    s_add_u32 m0, s80, 0x0
    s_add_u32 s56, s55, 0x0
    buffer_load_dwordx4 v10, s[24:27], s56 offen lds
    s_add_u32 m0, s80, 0x400
    s_add_u32 s56, s55, 0x0
    buffer_load_dwordx4 v11, s[24:27], s56 offen lds
    s_cmp_ge_u32 s58, 2
    s_cbranch_scc1 w3_72
    s_add_u32 m0, s80, 0x800
    s_add_u32 s56, s55, 0x0
    buffer_load_dwordx4 v12, s[24:27], s56 offen lds
w3_72:
    s_add_u32 s55, s55, 40960
    s_lshl_b32 s56, s62, 2
    s_mov_b32 m0, s57
    s_mov_b64 exec, 1
    buffer_load_dword v45, s[84:87], s56 offen lds
    s_mov_b64 exec, -1
    s_add_u32 s62, s62, 1
    s_add_u32 s78, s78, 1
    s_add_u32 s83, s83, 1
    s_cmp_eq_u32 s83, 7
    s_cselect_b32 s83, 0, s83
    s_mul_i32 s56, s71, 3
    s_add_u32 s56, s56, s70
    s_mul_i32 s56, s71, 7
    s_add_u32 s56, s56, s70
nb_73:
    s_sub_i32 s56, s77, 4
    s_lshl_b32 s82, s56, 1
    s_add_i32 s82, s82, 2
    s_add_i32 s89, s56, 11
    s_cmp_ge_i32 s56, 10
    s_cselect_b32 s82, s89, s82
    s_lshl_b32 s89, s56, 1
    s_sub_i32 s89, s89, 1
    s_cmp_ge_i32 s56, 13
    s_cselect_b32 s82, s89, s82
    s_cmp_ge_i32 s88, s82
    s_cbranch_scc1 gate_74_ok
gate_74:
    ds_read_b128 v[36:39], v22 offset:16
    s_waitcnt lgkmcnt(0)
    v_min3_u32 v36, v36, v37, v38
    v_min_u32 v36, v36, v39
    s_nop 0
    v_readfirstlane_b32 s88, v36
    s_add_u32 s63, s63, 1
    s_cmp_ge_i32 s88, s82
    s_cbranch_scc1 gate_74_ok
    s_cmp_gt_u32 s63, 300000
    s_cbranch_scc0 gate_74
gate_74_ok:
    s_waitcnt vmcnt(24)
    s_lshl_b32 s79, s94, 14
    s_add_u32 s79, s79, s65
    s_add_u32 s94, s94, 1
    s_cmp_eq_u32 s94, 4
    s_cselect_b32 s94, 0, s94
    s_add_u32 m0, s79, 0x0
    s_add_u32 s56, s54, 0x0
    buffer_load_dwordx4 v8, s[20:23], s56 offen lds
    s_add_u32 m0, s79, 0x400
    s_add_u32 s56, s54, 0xc00
    buffer_load_dwordx4 v9, s[20:23], s56 offen lds
    s_add_u32 m0, s79, 0x800
    s_add_u32 s56, s54, 0x1800
    buffer_load_dwordx4 v8, s[20:23], s56 offen lds
    s_add_u32 m0, s79, 0xc00
    s_add_u32 s56, s54, 0x2400
    buffer_load_dwordx4 v9, s[20:23], s56 offen lds
    s_add_u32 s62, s62, 1
    s_add_u32 s77, s77, 1
    s_add_u32 s54, s54, 128
    s_sub_i32 s82, s78, 6
    s_add_i32 s56, s82, 3
    s_cmp_ge_i32 s78, 27
    s_cselect_b32 s82, s56, s82
    s_cmp_ge_i32 s88, s82
    s_cbranch_scc1 gate_75_ok
gate_75:
    ds_read_b128 v[36:39], v22 offset:16
    s_waitcnt lgkmcnt(0)
    v_min3_u32 v36, v36, v37, v38
    v_min_u32 v36, v36, v39
    s_nop 0
    v_readfirstlane_b32 s88, v36
    s_add_u32 s63, s63, 1
    s_cmp_ge_i32 s88, s82
    s_cbranch_scc1 gate_75_ok
    s_cmp_gt_u32 s63, 300000
    s_cbranch_scc0 gate_75
gate_75_ok:
    s_mul_i32 s80, s83, 12288
    s_add_u32 s80, s80, s67
    s_add_u32 m0, s80, 0x0
    s_add_u32 s56, s55, 0x0
    buffer_load_dwordx4 v10, s[24:27], s56 offen lds
    s_add_u32 m0, s80, 0x400
    s_add_u32 s56, s55, 0x0
    buffer_load_dwordx4 v11, s[24:27], s56 offen lds
    s_cmp_ge_u32 s58, 2
    s_cbranch_scc1 w3_76
    s_add_u32 m0, s80, 0x800
    s_add_u32 s56, s55, 0x0
    buffer_load_dwordx4 v12, s[24:27], s56 offen lds
w3_76:
    s_add_u32 s55, s55, 40960
    s_add_u32 s62, s62, 1
    s_add_u32 s78, s78, 1
    s_add_u32 s83, s83, 1
    s_cmp_eq_u32 s83, 7
    s_cselect_b32 s83, 0, s83
    s_sub_i32 s82, s78, 6
    s_add_i32 s56, s82, 3
    s_cmp_ge_i32 s78, 27
    s_cselect_b32 s82, s56, s82
    s_cmp_ge_i32 s88, s82
    s_cbranch_scc1 gate_77_ok
gate_77:
    ds_read_b128 v[36:39], v22 offset:16
    s_waitcnt lgkmcnt(0)
    v_min3_u32 v36, v36, v37, v38
    v_min_u32 v36, v36, v39
    s_nop 0
    v_readfirstlane_b32 s88, v36
    s_add_u32 s63, s63, 1
    s_cmp_ge_i32 s88, s82
    s_cbranch_scc1 gate_77_ok
    s_cmp_gt_u32 s63, 300000
    s_cbranch_scc0 gate_77
gate_77_ok:
    s_mul_i32 s80, s83, 12288
    s_add_u32 s80, s80, s67
    s_add_u32 m0, s80, 0x0
    s_add_u32 s56, s55, 0x0
    buffer_load_dwordx4 v10, s[24:27], s56 offen lds
    s_add_u32 m0, s80, 0x400
    s_add_u32 s56, s55, 0x0
    buffer_load_dwordx4 v11, s[24:27], s56 offen lds
    s_cmp_ge_u32 s58, 2
    s_cbranch_scc1 w3_78
    s_add_u32 m0, s80, 0x800
    s_add_u32 s56, s55, 0x0
    buffer_load_dwordx4 v12, s[24:27], s56 offen lds
w3_78:
    s_add_u32 s55, s55, 40960
    s_lshl_b32 s56, s62, 2
    s_mov_b32 m0, s57
    s_mov_b64 exec, 1
    buffer_load_dword v45, s[84:87], s56 offen lds
    s_mov_b64 exec, -1
    s_add_u32 s62, s62, 1
    s_add_u32 s78, s78, 1
    s_add_u32 s83, s83, 1
    s_cmp_eq_u32 s83, 7
    s_cselect_b32 s83, 0, s83
    s_sub_i32 s56, s77, 4
    s_lshl_b32 s82, s56, 1
    s_add_i32 s82, s82, 2
    s_add_i32 s89, s56, 11
    s_cmp_ge_i32 s56, 10
    s_cselect_b32 s82, s89, s82
    s_lshl_b32 s89, s56, 1
    s_sub_i32 s89, s89, 1
    s_cmp_ge_i32 s56, 13
    s_cselect_b32 s82, s89, s82
    s_cmp_ge_i32 s88, s82
    s_cbranch_scc1 gate_79_ok
gate_79:
    ds_read_b128 v[36:39], v22 offset:16
    s_waitcnt lgkmcnt(0)
    v_min3_u32 v36, v36, v37, v38
    v_min_u32 v36, v36, v39
    s_nop 0
    v_readfirstlane_b32 s88, v36
    s_add_u32 s63, s63, 1
    s_cmp_ge_i32 s88, s82
    s_cbranch_scc1 gate_79_ok
    s_cmp_gt_u32 s63, 300000
    s_cbranch_scc0 gate_79
gate_79_ok:
    s_waitcnt vmcnt(24)
    s_lshl_b32 s79, s94, 14
    s_add_u32 s79, s79, s65
    s_add_u32 s94, s94, 1
    s_cmp_eq_u32 s94, 4
    s_cselect_b32 s94, 0, s94
    s_add_u32 m0, s79, 0x0
    s_add_u32 s56, s54, 0x0
    buffer_load_dwordx4 v8, s[20:23], s56 offen lds
    s_add_u32 m0, s79, 0x400
    s_add_u32 s56, s54, 0xc00
    buffer_load_dwordx4 v9, s[20:23], s56 offen lds
    s_add_u32 m0, s79, 0x800
    s_add_u32 s56, s54, 0x1800
    buffer_load_dwordx4 v8, s[20:23], s56 offen lds
    s_add_u32 m0, s79, 0xc00
    s_add_u32 s56, s54, 0x2400
    buffer_load_dwordx4 v9, s[20:23], s56 offen lds
    s_add_u32 s62, s62, 1
    s_add_u32 s77, s77, 1
    s_add_u32 s54, s54, 128
    s_sub_i32 s82, s78, 6
    s_add_i32 s56, s82, 3
    s_cmp_ge_i32 s78, 27
    s_cselect_b32 s82, s56, s82
    s_cmp_ge_i32 s88, s82
    s_cbranch_scc1 gate_80_ok
gate_80:
    ds_read_b128 v[36:39], v22 offset:16
    s_waitcnt lgkmcnt(0)
    v_min3_u32 v36, v36, v37, v38
    v_min_u32 v36, v36, v39
    s_nop 0
    v_readfirstlane_b32 s88, v36
    s_add_u32 s63, s63, 1
    s_cmp_ge_i32 s88, s82
    s_cbranch_scc1 gate_80_ok
    s_cmp_gt_u32 s63, 300000
    s_cbranch_scc0 gate_80
gate_80_ok:
    s_mul_i32 s80, s83, 12288
    s_add_u32 s80, s80, s67
    s_add_u32 m0, s80, 0x0
    s_add_u32 s56, s55, 0x0
    buffer_load_dwordx4 v10, s[24:27], s56 offen lds
    s_add_u32 m0, s80, 0x400
    s_add_u32 s56, s55, 0x0
    buffer_load_dwordx4 v11, s[24:27], s56 offen lds
    s_cmp_ge_u32 s58, 2
    s_cbranch_scc1 w3_81
    s_add_u32 m0, s80, 0x800
    s_add_u32 s56, s55, 0x0
    buffer_load_dwordx4 v12, s[24:27], s56 offen lds
w3_81:
    s_add_u32 s55, s55, 40960
    s_add_u32 s62, s62, 1
    s_add_u32 s78, s78, 1
    s_add_u32 s83, s83, 1
    s_cmp_eq_u32 s83, 7
    s_cselect_b32 s83, 0, s83
    s_sub_i32 s82, s78, 6
    s_add_i32 s56, s82, 3
    s_cmp_ge_i32 s78, 27
    s_cselect_b32 s82, s56, s82
    s_cmp_ge_i32 s88, s82
    s_cbranch_scc1 gate_82_ok
gate_82:
    ds_read_b128 v[36:39], v22 offset:16
    s_waitcnt lgkmcnt(0)
    v_min3_u32 v36, v36, v37, v38
    v_min_u32 v36, v36, v39
    s_nop 0
    v_readfirstlane_b32 s88, v36
    s_add_u32 s63, s63, 1
    s_cmp_ge_i32 s88, s82
    s_cbranch_scc1 gate_82_ok
    s_cmp_gt_u32 s63, 300000
    s_cbranch_scc0 gate_82
gate_82_ok:
    s_mul_i32 s80, s83, 12288
    s_add_u32 s80, s80, s67
    s_add_u32 m0, s80, 0x0
    s_add_u32 s56, s55, 0x0
    buffer_load_dwordx4 v10, s[24:27], s56 offen lds
    s_add_u32 m0, s80, 0x400
    s_add_u32 s56, s55, 0x0
    buffer_load_dwordx4 v11, s[24:27], s56 offen lds
    s_cmp_ge_u32 s58, 2
    s_cbranch_scc1 w3_83
    s_add_u32 m0, s80, 0x800
    s_add_u32 s56, s55, 0x0
    buffer_load_dwordx4 v12, s[24:27], s56 offen lds
w3_83:
    s_add_u32 s55, s55, 40960
    s_lshl_b32 s56, s62, 2
    s_mov_b32 m0, s57
    s_mov_b64 exec, 1
    buffer_load_dword v45, s[84:87], s56 offen lds
    s_mov_b64 exec, -1
    s_add_u32 s62, s62, 1
    s_add_u32 s78, s78, 1
    s_add_u32 s83, s83, 1
    s_cmp_eq_u32 s83, 7
    s_cselect_b32 s83, 0, s83
    s_sub_i32 s56, s77, 4
    s_lshl_b32 s82, s56, 1
    s_add_i32 s82, s82, 2
    s_add_i32 s89, s56, 11
    s_cmp_ge_i32 s56, 10
    s_cselect_b32 s82, s89, s82
    s_lshl_b32 s89, s56, 1
    s_sub_i32 s89, s89, 1
    s_cmp_ge_i32 s56, 13
    s_cselect_b32 s82, s89, s82
    s_cmp_ge_i32 s88, s82
    s_cbranch_scc1 gate_84_ok
gate_84:
    ds_read_b128 v[36:39], v22 offset:16
    s_waitcnt lgkmcnt(0)
    v_min3_u32 v36, v36, v37, v38
    v_min_u32 v36, v36, v39
    s_nop 0
    v_readfirstlane_b32 s88, v36
    s_add_u32 s63, s63, 1
    s_cmp_ge_i32 s88, s82
    s_cbranch_scc1 gate_84_ok
    s_cmp_gt_u32 s63, 300000
    s_cbranch_scc0 gate_84
gate_84_ok:
    s_waitcnt vmcnt(24)
    s_lshl_b32 s79, s94, 14
    s_add_u32 s79, s79, s65
    s_add_u32 s94, s94, 1
    s_cmp_eq_u32 s94, 4
    s_cselect_b32 s94, 0, s94
    s_add_u32 m0, s79, 0x0
    s_add_u32 s56, s54, 0x0
    buffer_load_dwordx4 v8, s[20:23], s56 offen lds
    s_add_u32 m0, s79, 0x400
    s_add_u32 s56, s54, 0xc00
    buffer_load_dwordx4 v9, s[20:23], s56 offen lds
    s_add_u32 m0, s79, 0x800
    s_add_u32 s56, s54, 0x1800
    buffer_load_dwordx4 v8, s[20:23], s56 offen lds
    s_add_u32 m0, s79, 0xc00
    s_add_u32 s56, s54, 0x2400
    buffer_load_dwordx4 v9, s[20:23], s56 offen lds
    s_add_u32 s62, s62, 1
    s_add_u32 s77, s77, 1
    s_add_u32 s54, s54, 12032
    s_sub_i32 s82, s78, 6
    s_add_i32 s56, s82, 3
    s_cmp_ge_i32 s78, 27
    s_cselect_b32 s82, s56, s82
    s_cmp_ge_i32 s88, s82
    s_cbranch_scc1 gate_85_ok
gate_85:
    ds_read_b128 v[36:39], v22 offset:16
    s_waitcnt lgkmcnt(0)
    v_min3_u32 v36, v36, v37, v38
    v_min_u32 v36, v36, v39
    s_nop 0
    v_readfirstlane_b32 s88, v36
    s_add_u32 s63, s63, 1
    s_cmp_ge_i32 s88, s82
    s_cbranch_scc1 gate_85_ok
    s_cmp_gt_u32 s63, 300000
    s_cbranch_scc0 gate_85
gate_85_ok:
    s_mul_i32 s80, s83, 12288
    s_add_u32 s80, s80, s67
    s_add_u32 m0, s80, 0x0
    s_add_u32 s56, s55, 0x0
    buffer_load_dwordx4 v10, s[24:27], s56 offen lds
    s_add_u32 m0, s80, 0x400
    s_add_u32 s56, s55, 0x0
    buffer_load_dwordx4 v11, s[24:27], s56 offen lds
    s_cmp_ge_u32 s58, 2
    s_cbranch_scc1 w3_86
    s_add_u32 m0, s80, 0x800
    s_add_u32 s56, s55, 0x0
    buffer_load_dwordx4 v12, s[24:27], s56 offen lds
w3_86:
    s_add_u32 s55, s55, 40960
    s_add_u32 s62, s62, 1
    s_add_u32 s78, s78, 1
    s_add_u32 s83, s83, 1
    s_cmp_eq_u32 s83, 7
    s_cselect_b32 s83, 0, s83
    s_sub_i32 s82, s78, 6
    s_add_i32 s56, s82, 3
    s_cmp_ge_i32 s78, 27
    s_cselect_b32 s82, s56, s82
    s_cmp_ge_i32 s88, s82
    s_cbranch_scc1 gate_87_ok
gate_87:
    ds_read_b128 v[36:39], v22 offset:16
    s_waitcnt lgkmcnt(0)
    v_min3_u32 v36, v36, v37, v38
    v_min_u32 v36, v36, v39
    s_nop 0
    v_readfirstlane_b32 s88, v36
    s_add_u32 s63, s63, 1
    s_cmp_ge_i32 s88, s82
    s_cbranch_scc1 gate_87_ok
    s_cmp_gt_u32 s63, 300000
    s_cbranch_scc0 gate_87
gate_87_ok:
    s_mul_i32 s80, s83, 12288
    s_add_u32 s80, s80, s67
    s_add_u32 m0, s80, 0x0
    s_add_u32 s56, s55, 0x0
    buffer_load_dwordx4 v10, s[24:27], s56 offen lds
    s_add_u32 m0, s80, 0x400
    s_add_u32 s56, s55, 0x0
    buffer_load_dwordx4 v11, s[24:27], s56 offen lds
    s_cmp_ge_u32 s58, 2
    s_cbranch_scc1 w3_88
    s_add_u32 m0, s80, 0x800
    s_add_u32 s56, s55, 0x0
    buffer_load_dwordx4 v12, s[24:27], s56 offen lds
w3_88:
    s_add_u32 s55, s55, 40960
    s_lshl_b32 s56, s62, 2
    s_mov_b32 m0, s57
    s_mov_b64 exec, 1
    buffer_load_dword v45, s[84:87], s56 offen lds
    s_mov_b64 exec, -1
    s_add_u32 s62, s62, 1
    s_add_u32 s78, s78, 1
    s_add_u32 s83, s83, 1
    s_cmp_eq_u32 s83, 7
    s_cselect_b32 s83, 0, s83
    s_sub_i32 s56, s77, 4
    s_lshl_b32 s82, s56, 1
    s_add_i32 s82, s82, 2
    s_add_i32 s89, s56, 11
    s_cmp_ge_i32 s56, 10
    s_cselect_b32 s82, s89, s82
    s_lshl_b32 s89, s56, 1
    s_sub_i32 s89, s89, 1
    s_cmp_ge_i32 s56, 13
    s_cselect_b32 s82, s89, s82
    s_cmp_ge_i32 s88, s82
    s_cbranch_scc1 gate_89_ok
gate_89:
    ds_read_b128 v[36:39], v22 offset:16
    s_waitcnt lgkmcnt(0)
    v_min3_u32 v36, v36, v37, v38
    v_min_u32 v36, v36, v39
    s_nop 0
    v_readfirstlane_b32 s88, v36
    s_add_u32 s63, s63, 1
    s_cmp_ge_i32 s88, s82
    s_cbranch_scc1 gate_89_ok
    s_cmp_gt_u32 s63, 300000
    s_cbranch_scc0 gate_89
gate_89_ok:
    s_waitcnt vmcnt(24)
    s_lshl_b32 s79, s94, 14
    s_add_u32 s79, s79, s65
    s_add_u32 s94, s94, 1
    s_cmp_eq_u32 s94, 4
    s_cselect_b32 s94, 0, s94
    s_add_u32 m0, s79, 0x0
    s_add_u32 s56, s54, 0x0
    buffer_load_dwordx4 v8, s[20:23], s56 offen lds
    s_add_u32 m0, s79, 0x400
    s_add_u32 s56, s54, 0xc00
    buffer_load_dwordx4 v9, s[20:23], s56 offen lds
    s_add_u32 m0, s79, 0x800
    s_add_u32 s56, s54, 0x1800
    buffer_load_dwordx4 v8, s[20:23], s56 offen lds
    s_add_u32 m0, s79, 0xc00
    s_add_u32 s56, s54, 0x2400
    buffer_load_dwordx4 v9, s[20:23], s56 offen lds
    s_add_u32 s62, s62, 1
    s_add_u32 s77, s77, 1
    s_add_u32 s54, s54, 128
    s_sub_i32 s82, s78, 6
    s_add_i32 s56, s82, 3
    s_cmp_ge_i32 s78, 27
    s_cselect_b32 s82, s56, s82
    s_cmp_ge_i32 s88, s82
    s_cbranch_scc1 gate_90_ok
gate_90:
    ds_read_b128 v[36:39], v22 offset:16
    s_waitcnt lgkmcnt(0)
    v_min3_u32 v36, v36, v37, v38
    v_min_u32 v36, v36, v39
    s_nop 0
    v_readfirstlane_b32 s88, v36
    s_add_u32 s63, s63, 1
    s_cmp_ge_i32 s88, s82
    s_cbranch_scc1 gate_90_ok
    s_cmp_gt_u32 s63, 300000
    s_cbranch_scc0 gate_90
gate_90_ok:
    s_mul_i32 s80, s83, 12288
    s_add_u32 s80, s80, s67
    s_add_u32 m0, s80, 0x0
    s_add_u32 s56, s55, 0x0
    buffer_load_dwordx4 v10, s[24:27], s56 offen lds
    s_add_u32 m0, s80, 0x400
    s_add_u32 s56, s55, 0x0
    buffer_load_dwordx4 v11, s[24:27], s56 offen lds
    s_cmp_ge_u32 s58, 2
    s_cbranch_scc1 w3_91
    s_add_u32 m0, s80, 0x800
    s_add_u32 s56, s55, 0x0
    buffer_load_dwordx4 v12, s[24:27], s56 offen lds
w3_91:
    s_add_u32 s55, s55, 40960
    s_add_u32 s62, s62, 1
    s_add_u32 s78, s78, 1
    s_add_u32 s83, s83, 1
    s_cmp_eq_u32 s83, 7
    s_cselect_b32 s83, 0, s83
    s_sub_i32 s82, s78, 6
    s_add_i32 s56, s82, 3
    s_cmp_ge_i32 s78, 27
    s_cselect_b32 s82, s56, s82
    s_cmp_ge_i32 s88, s82
    s_cbranch_scc1 gate_92_ok
gate_92:
    ds_read_b128 v[36:39], v22 offset:16
    s_waitcnt lgkmcnt(0)
    v_min3_u32 v36, v36, v37, v38
    v_min_u32 v36, v36, v39
    s_nop 0
    v_readfirstlane_b32 s88, v36
    s_add_u32 s63, s63, 1
    s_cmp_ge_i32 s88, s82
    s_cbranch_scc1 gate_92_ok
    s_cmp_gt_u32 s63, 300000
    s_cbranch_scc0 gate_92
gate_92_ok:
    s_mul_i32 s80, s83, 12288
    s_add_u32 s80, s80, s67
    s_add_u32 m0, s80, 0x0
    s_add_u32 s56, s55, 0x0
    buffer_load_dwordx4 v10, s[24:27], s56 offen lds
    s_add_u32 m0, s80, 0x400
    s_add_u32 s56, s55, 0x0
    buffer_load_dwordx4 v11, s[24:27], s56 offen lds
    s_cmp_ge_u32 s58, 2
    s_cbranch_scc1 w3_93
    s_add_u32 m0, s80, 0x800
    s_add_u32 s56, s55, 0x0
    buffer_load_dwordx4 v12, s[24:27], s56 offen lds
w3_93:
    s_add_u32 s55, s55, 40960
    s_lshl_b32 s56, s62, 2
    s_mov_b32 m0, s57
    s_mov_b64 exec, 1
    buffer_load_dword v45, s[84:87], s56 offen lds
    s_mov_b64 exec, -1
    s_add_u32 s62, s62, 1
    s_add_u32 s78, s78, 1
    s_add_u32 s83, s83, 1
    s_cmp_eq_u32 s83, 7
    s_cselect_b32 s83, 0, s83
    s_sub_i32 s56, s77, 4
    s_lshl_b32 s82, s56, 1
    s_add_i32 s82, s82, 2
    s_add_i32 s89, s56, 11
    s_cmp_ge_i32 s56, 10
    s_cselect_b32 s82, s89, s82
    s_lshl_b32 s89, s56, 1
    s_sub_i32 s89, s89, 1
    s_cmp_ge_i32 s56, 13
    s_cselect_b32 s82, s89, s82
    s_cmp_ge_i32 s88, s82
    s_cbranch_scc1 gate_94_ok
gate_94:
    ds_read_b128 v[36:39], v22 offset:16
    s_waitcnt lgkmcnt(0)
    v_min3_u32 v36, v36, v37, v38
    v_min_u32 v36, v36, v39
    s_nop 0
    v_readfirstlane_b32 s88, v36
    s_add_u32 s63, s63, 1
    s_cmp_ge_i32 s88, s82
    s_cbranch_scc1 gate_94_ok
    s_cmp_gt_u32 s63, 300000
    s_cbranch_scc0 gate_94
gate_94_ok:
    s_waitcnt vmcnt(24)
    s_lshl_b32 s79, s94, 14
    s_add_u32 s79, s79, s65
    s_add_u32 s94, s94, 1
    s_cmp_eq_u32 s94, 4
    s_cselect_b32 s94, 0, s94
    s_add_u32 m0, s79, 0x0
    s_add_u32 s56, s54, 0x0
    buffer_load_dwordx4 v8, s[20:23], s56 offen lds
    s_add_u32 m0, s79, 0x400
    s_add_u32 s56, s54, 0xc00
    buffer_load_dwordx4 v9, s[20:23], s56 offen lds
    s_add_u32 m0, s79, 0x800
    s_add_u32 s56, s54, 0x1800
    buffer_load_dwordx4 v8, s[20:23], s56 offen lds
    s_add_u32 m0, s79, 0xc00
    s_add_u32 s56, s54, 0x2400
    buffer_load_dwordx4 v9, s[20:23], s56 offen lds
    s_add_u32 s62, s62, 1
    s_add_u32 s77, s77, 1
    s_add_u32 s54, s54, 128
    s_sub_i32 s82, s78, 6
    s_add_i32 s56, s82, 3
    s_cmp_ge_i32 s78, 27
    s_cselect_b32 s82, s56, s82
    s_cmp_ge_i32 s88, s82
    s_cbranch_scc1 gate_95_ok
gate_95:
    ds_read_b128 v[36:39], v22 offset:16
    s_waitcnt lgkmcnt(0)
    v_min3_u32 v36, v36, v37, v38
    v_min_u32 v36, v36, v39
    s_nop 0
    v_readfirstlane_b32 s88, v36
    s_add_u32 s63, s63, 1
    s_cmp_ge_i32 s88, s82
    s_cbranch_scc1 gate_95_ok
    s_cmp_gt_u32 s63, 300000
    s_cbranch_scc0 gate_95
gate_95_ok:
    s_mul_i32 s80, s83, 12288
    s_add_u32 s80, s80, s67
    s_add_u32 m0, s80, 0x0
    s_add_u32 s56, s55, 0x0
    buffer_load_dwordx4 v10, s[24:27], s56 offen lds
    s_add_u32 m0, s80, 0x400
    s_add_u32 s56, s55, 0x0
    buffer_load_dwordx4 v11, s[24:27], s56 offen lds
    s_cmp_ge_u32 s58, 2
    s_cbranch_scc1 w3_96
    s_add_u32 m0, s80, 0x800
    s_add_u32 s56, s55, 0x0
    buffer_load_dwordx4 v12, s[24:27], s56 offen lds
w3_96:
    s_add_u32 s55, s55, 40960
    s_add_u32 s62, s62, 1
    s_add_u32 s78, s78, 1
    s_add_u32 s83, s83, 1
    s_cmp_eq_u32 s83, 7
    s_cselect_b32 s83, 0, s83
    s_sub_i32 s82, s78, 6
    s_add_i32 s56, s82, 3
    s_cmp_ge_i32 s78, 27
    s_cselect_b32 s82, s56, s82
    s_cmp_ge_i32 s88, s82
    s_cbranch_scc1 gate_97_ok
gate_97:
    ds_read_b128 v[36:39], v22 offset:16
    s_waitcnt lgkmcnt(0)
    v_min3_u32 v36, v36, v37, v38
    v_min_u32 v36, v36, v39
    s_nop 0
    v_readfirstlane_b32 s88, v36
    s_add_u32 s63, s63, 1
    s_cmp_ge_i32 s88, s82
    s_cbranch_scc1 gate_97_ok
    s_cmp_gt_u32 s63, 300000
    s_cbranch_scc0 gate_97
gate_97_ok:
    s_mul_i32 s80, s83, 12288
    s_add_u32 s80, s80, s67
    s_add_u32 m0, s80, 0x0
    s_add_u32 s56, s55, 0x0
    buffer_load_dwordx4 v10, s[24:27], s56 offen lds
    s_add_u32 m0, s80, 0x400
    s_add_u32 s56, s55, 0x0
    buffer_load_dwordx4 v11, s[24:27], s56 offen lds
    s_cmp_ge_u32 s58, 2
    s_cbranch_scc1 w3_98
    s_add_u32 m0, s80, 0x800
    s_add_u32 s56, s55, 0x0
    buffer_load_dwordx4 v12, s[24:27], s56 offen lds
w3_98:
    s_add_u32 s55, s55, 40960
    s_lshl_b32 s56, s62, 2
    s_mov_b32 m0, s57
    s_mov_b64 exec, 1
    buffer_load_dword v45, s[84:87], s56 offen lds
    s_mov_b64 exec, -1
    s_add_u32 s62, s62, 1
    s_add_u32 s78, s78, 1
    s_add_u32 s83, s83, 1
    s_cmp_eq_u32 s83, 7
    s_cselect_b32 s83, 0, s83
    s_sub_i32 s56, s77, 4
    s_lshl_b32 s82, s56, 1
    s_add_i32 s82, s82, 2
    s_add_i32 s89, s56, 11
    s_cmp_ge_i32 s56, 10
    s_cselect_b32 s82, s89, s82
    s_lshl_b32 s89, s56, 1
    s_sub_i32 s89, s89, 1
    s_cmp_ge_i32 s56, 13
    s_cselect_b32 s82, s89, s82
    s_cmp_ge_i32 s88, s82
    s_cbranch_scc1 gate_99_ok
gate_99:
    ds_read_b128 v[36:39], v22 offset:16
    s_waitcnt lgkmcnt(0)
    v_min3_u32 v36, v36, v37, v38
    v_min_u32 v36, v36, v39
    s_nop 0
    v_readfirstlane_b32 s88, v36
    s_add_u32 s63, s63, 1
    s_cmp_ge_i32 s88, s82
    s_cbranch_scc1 gate_99_ok
    s_cmp_gt_u32 s63, 300000
    s_cbranch_scc0 gate_99
gate_99_ok:
    s_waitcnt vmcnt(24)
    s_lshl_b32 s79, s94, 14
    s_add_u32 s79, s79, s65
    s_add_u32 s94, s94, 1
    s_cmp_eq_u32 s94, 4
    s_cselect_b32 s94, 0, s94
    s_add_u32 m0, s79, 0x0
    s_add_u32 s56, s54, 0x0
    buffer_load_dwordx4 v8, s[20:23], s56 offen lds
    s_add_u32 m0, s79, 0x400
    s_add_u32 s56, s54, 0xc00
    buffer_load_dwordx4 v9, s[20:23], s56 offen lds
    s_add_u32 m0, s79, 0x800
    s_add_u32 s56, s54, 0x1800
    buffer_load_dwordx4 v8, s[20:23], s56 offen lds
    s_add_u32 m0, s79, 0xc00
    s_add_u32 s56, s54, 0x2400
    buffer_load_dwordx4 v9, s[20:23], s56 offen lds
    s_add_u32 s62, s62, 1
    s_add_u32 s77, s77, 1
    s_add_u32 s54, s54, 12032
    s_sub_i32 s82, s78, 6
    s_add_i32 s56, s82, 3
    s_cmp_ge_i32 s78, 27
    s_cselect_b32 s82, s56, s82
    s_cmp_ge_i32 s88, s82
    s_cbranch_scc1 gate_100_ok
gate_100:
    ds_read_b128 v[36:39], v22 offset:16
    s_waitcnt lgkmcnt(0)
    v_min3_u32 v36, v36, v37, v38
    v_min_u32 v36, v36, v39
    s_nop 0
    v_readfirstlane_b32 s88, v36
    s_add_u32 s63, s63, 1
    s_cmp_ge_i32 s88, s82
    s_cbranch_scc1 gate_100_ok
    s_cmp_gt_u32 s63, 300000
    s_cbranch_scc0 gate_100
gate_100_ok:
    s_mul_i32 s80, s83, 12288
    s_add_u32 s80, s80, s67
    s_add_u32 m0, s80, 0x0
    s_add_u32 s56, s55, 0x0
    buffer_load_dwordx4 v10, s[24:27], s56 offen lds
    s_add_u32 m0, s80, 0x400
    s_add_u32 s56, s55, 0x0
    buffer_load_dwordx4 v11, s[24:27], s56 offen lds
    s_cmp_ge_u32 s58, 2
    s_cbranch_scc1 w3_101
    s_add_u32 m0, s80, 0x800
    s_add_u32 s56, s55, 0x0
    buffer_load_dwordx4 v12, s[24:27], s56 offen lds
w3_101:
    s_add_u32 s55, s55, 40960
    s_add_u32 s62, s62, 1
    s_add_u32 s78, s78, 1
    s_add_u32 s83, s83, 1
    s_cmp_eq_u32 s83, 7
    s_cselect_b32 s83, 0, s83
    s_sub_i32 s82, s78, 6
    s_add_i32 s56, s82, 3
    s_cmp_ge_i32 s78, 27
    s_cselect_b32 s82, s56, s82
    s_cmp_ge_i32 s88, s82
    s_cbranch_scc1 gate_102_ok
gate_102:
    ds_read_b128 v[36:39], v22 offset:16
    s_waitcnt lgkmcnt(0)
    v_min3_u32 v36, v36, v37, v38
    v_min_u32 v36, v36, v39
    s_nop 0
    v_readfirstlane_b32 s88, v36
    s_add_u32 s63, s63, 1
    s_cmp_ge_i32 s88, s82
    s_cbranch_scc1 gate_102_ok
    s_cmp_gt_u32 s63, 300000
    s_cbranch_scc0 gate_102
gate_102_ok:
    s_mul_i32 s80, s83, 12288
    s_add_u32 s80, s80, s67
    s_add_u32 m0, s80, 0x0
    s_add_u32 s56, s55, 0x0
    buffer_load_dwordx4 v10, s[24:27], s56 offen lds
    s_add_u32 m0, s80, 0x400
    s_add_u32 s56, s55, 0x0
    buffer_load_dwordx4 v11, s[24:27], s56 offen lds
    s_cmp_ge_u32 s58, 2
    s_cbranch_scc1 w3_103
    s_add_u32 m0, s80, 0x800
    s_add_u32 s56, s55, 0x0
    buffer_load_dwordx4 v12, s[24:27], s56 offen lds
w3_103:
    s_add_u32 s55, s55, 40960
    s_lshl_b32 s56, s62, 2
    s_mov_b32 m0, s57
    s_mov_b64 exec, 1
    buffer_load_dword v45, s[84:87], s56 offen lds
    s_mov_b64 exec, -1
    s_add_u32 s62, s62, 1
    s_add_u32 s78, s78, 1
    s_add_u32 s83, s83, 1
    s_cmp_eq_u32 s83, 7
    s_cselect_b32 s83, 0, s83
    s_waitcnt vmcnt(0)
    s_waitcnt lgkmcnt(0)
    s_endpgm
computew:
    s_mov_b32 s63, 0
    v_mov_b32 v14, 0x25000
    v_and_b32 v248, 3, v0
    v_lshl_add_u32 v10, v248, 2, v14
    v_lshlrev_b32 v248, 2, v0
    v_add_u32 v1, 0x25040, v248
    s_lshl_b32 s58, s3, 2
    s_add_u32 s58, s58, 0x25010
    v_writelane_b32 v1, s58, 0
    v_mov_b32 v15, 0
    v_and_b32 v248, 31, v0
    v_lshrrev_b32 v249, 5, v0
    v_bfe_u32 v250, v0, 1, 3
    v_xor_b32 v250, v250, v249
    s_lshl_b32 s47, s3, 12
    v_lshlrev_b32 v251, 7, v248
    v_add_u32 v251, s47, v251
    v_xor_b32 v2, 0, v250
    v_lshl_add_u32 v2, v2, 4, v251
    v_add_u32 v252, 0x10000, v2
    v_xor_b32 v3, 2, v250
    v_lshl_add_u32 v3, v3, 4, v251
    v_add_u32 v253, 0x10000, v3
    v_xor_b32 v4, 4, v250
    v_lshl_add_u32 v4, v4, 4, v251
    v_add_u32 v254, 0x10000, v4
    v_xor_b32 v5, 6, v250
    v_lshl_add_u32 v5, v5, 4, v251
    v_add_u32 v255, 0x10000, v5
    v_bfe_u32 v248, v0, 2, 2
    v_lshrrev_b32 v249, 5, v0
    v_lshl_add_u32 v248, v249, 3, v248
    v_mul_u32_u24 v248, 384, v248
    v_bfe_u32 v249, v0, 4, 1
    v_lshl_add_u32 v248, v249, 5, v248
    v_and_b32 v249, 1, v0
    v_lshl_add_u32 v248, v249, 4, v248
    v_bfe_u32 v249, v0, 1, 1
    v_lshl_add_u32 v248, v249, 3, v248
    v_add_u32 v248, 0x10000, v248
    v_bfe_u32 v249, v0, 3, 1
    v_lshlrev_b32 v249, 6, v249
    v_add_u32 v6, v248, v249
    v_sub_u32 v7, v248, v249
    v_add_u32 v8, 49152, v6
    v_add_u32 v9, 49152, v7
    v_lshlrev_b32 v11, 4, v0
    s_waitcnt lgkmcnt(0)
    s_barrier
    ds_read_b32 v12, v10
    s_waitcnt lgkmcnt(0)
    v_cmp_gt_u32 vcc, 3, v12
    s_nop 4
    s_mov_b32 s61, 3
    s_getpc_b64 s[56:57]
    s_cbranch_vccnz common_slow
    ds_read_b128 v[160:163], v2 offset:0
    ds_read_b64_tr_b16 v[112:113], v6 offset:0
    ds_read_b64_tr_b16 v[114:115], v6 offset:1536
    ds_read_b64_tr_b16 v[116:117], v7 offset:64
    ds_read_b64_tr_b16 v[118:119], v7 offset:1600
    ds_read_b64_tr_b16 v[120:121], v6 offset:128
    ds_read_b64_tr_b16 v[122:123], v6 offset:1664
    ds_read_b64_tr_b16 v[124:125], v7 offset:192
    ds_read_b64_tr_b16 v[126:127], v7 offset:1728
    ds_read_b64_tr_b16 v[128:129], v6 offset:256
    ds_read_b64_tr_b16 v[130:131], v6 offset:1792
    ds_read_b64_tr_b16 v[132:133], v7 offset:320
    ds_read_b64_tr_b16 v[134:135], v7 offset:1856
    s_waitcnt lgkmcnt(10)
    v_mfma_f32_32x32x16_bf16 v[16:31], v[112:115], v[160:163], 0
    ds_read_b128 v[164:167], v3 offset:0
    ds_read_b64_tr_b16 v[136:137], v6 offset:6144
    ds_read_b64_tr_b16 v[138:139], v6 offset:7680
    ds_read_b64_tr_b16 v[140:141], v7 offset:6208
    s_waitcnt lgkmcnt(12)
    v_mfma_f32_32x32x16_bf16 v[32:47], v[116:119], v[160:163], 0
    ds_read_b64_tr_b16 v[142:143], v7 offset:7744
    ds_read_b64_tr_b16 v[144:145], v6 offset:6272
    ds_read_b64_tr_b16 v[146:147], v6 offset:7808
    s_waitcnt lgkmcnt(13)
    v_mfma_f32_32x32x16_bf16 v[48:63], v[120:123], v[160:163], 0
    ds_read_b64_tr_b16 v[148:149], v7 offset:6336
    ds_read_b64_tr_b16 v[150:151], v7 offset:7872
    ds_read_b64_tr_b16 v[152:153], v6 offset:6400
    s_waitcnt lgkmcnt(14)
    v_mfma_f32_32x32x16_bf16 v[64:79], v[124:127], v[160:163], 0
    ds_read_b64_tr_b16 v[154:155], v6 offset:7936
    ds_read_b64_tr_b16 v[156:157], v7 offset:6464
    ds_read_b64_tr_b16 v[158:159], v7 offset:8000
    s_waitcnt lgkmcnt(15)
    v_mfma_f32_32x32x16_bf16 v[80:95], v[128:131], v[160:163], 0
    s_waitcnt lgkmcnt(13)
    v_mfma_f32_32x32x16_bf16 v[96:111], v[132:135], v[160:163], 0
    s_waitcnt lgkmcnt(10)
    v_mfma_f32_32x32x16_bf16 v[16:31], v[136:139], v[164:167], v[16:31]
    s_waitcnt lgkmcnt(0)
    v_add_u32 v15, 1, v15
    v_mfma_f32_32x32x16_bf16 v[32:47], v[140:143], v[164:167], v[32:47]
    ds_read_b128 v[160:163], v4 offset:0
    ds_read_b64_tr_b16 v[112:113], v6 offset:12288
    ds_read_b64_tr_b16 v[114:115], v6 offset:13824
    ds_read_b64_tr_b16 v[116:117], v7 offset:12352
    v_mfma_f32_32x32x16_bf16 v[48:63], v[144:147], v[164:167], v[48:63]
    ds_read_b64_tr_b16 v[118:119], v7 offset:13888
    ds_read_b64_tr_b16 v[120:121], v6 offset:12416
    ds_read_b64_tr_b16 v[122:123], v6 offset:13952
    v_mfma_f32_32x32x16_bf16 v[64:79], v[148:151], v[164:167], v[64:79]
    ds_read_b64_tr_b16 v[124:125], v7 offset:12480
    ds_read_b64_tr_b16 v[126:127], v7 offset:14016
    ds_read_b64_tr_b16 v[128:129], v6 offset:12544
    v_mfma_f32_32x32x16_bf16 v[80:95], v[152:155], v[164:167], v[80:95]
    ds_read_b64_tr_b16 v[130:131], v6 offset:14080
    ds_read_b64_tr_b16 v[132:133], v7 offset:12608
    ds_read_b64_tr_b16 v[134:135], v7 offset:14144
    v_mfma_f32_32x32x16_bf16 v[96:111], v[156:159], v[164:167], v[96:111]
    s_waitcnt lgkmcnt(10)
    v_mfma_f32_32x32x16_bf16 v[16:31], v[112:115], v[160:163], v[16:31]
    ds_read_b128 v[164:167], v5 offset:0
    ds_read_b64_tr_b16 v[136:137], v6 offset:18432
    ds_read_b64_tr_b16 v[138:139], v6 offset:19968
    ds_read_b64_tr_b16 v[140:141], v7 offset:18496
    s_waitcnt lgkmcnt(12)
    v_mfma_f32_32x32x16_bf16 v[32:47], v[116:119], v[160:163], v[32:47]
    ds_read_b64_tr_b16 v[142:143], v7 offset:20032
    ds_read_b64_tr_b16 v[144:145], v6 offset:18560
    ds_read_b64_tr_b16 v[146:147], v6 offset:20096
    s_waitcnt lgkmcnt(13)
    v_mfma_f32_32x32x16_bf16 v[48:63], v[120:123], v[160:163], v[48:63]
    ds_read_b64_tr_b16 v[148:149], v7 offset:18624
    ds_read_b64_tr_b16 v[150:151], v7 offset:20160
    ds_read_b64_tr_b16 v[152:153], v6 offset:18688
    s_waitcnt lgkmcnt(14)
    v_mfma_f32_32x32x16_bf16 v[64:79], v[124:127], v[160:163], v[64:79]
    ds_read_b64_tr_b16 v[154:155], v6 offset:20224
    ds_read_b64_tr_b16 v[156:157], v7 offset:18752
    ds_read_b64_tr_b16 v[158:159], v7 offset:20288
    s_waitcnt lgkmcnt(15)
    v_mfma_f32_32x32x16_bf16 v[80:95], v[128:131], v[160:163], v[80:95]
    ds_read_b32 v12, v10
    s_waitcnt lgkmcnt(14)
    v_mfma_f32_32x32x16_bf16 v[96:111], v[132:135], v[160:163], v[96:111]
    s_waitcnt lgkmcnt(11)
    v_mfma_f32_32x32x16_bf16 v[16:31], v[136:139], v[164:167], v[16:31]
    s_waitcnt lgkmcnt(0)
    v_cmp_gt_u32 vcc, 6, v12
    v_add_u32 v15, 1, v15
    ds_write_b32 v1, v15
    v_mfma_f32_32x32x16_bf16 v[32:47], v[140:143], v[164:167], v[32:47]
    s_mov_b32 s61, 6
    s_getpc_b64 s[56:57]
    s_cbranch_vccnz common_slow
    ds_read_b128 v[160:163], v2 offset:16384
    ds_read_b64_tr_b16 v[112:113], v6 offset:24576
    ds_read_b64_tr_b16 v[114:115], v6 offset:26112
    ds_read_b64_tr_b16 v[116:117], v7 offset:24640
    v_mfma_f32_32x32x16_bf16 v[48:63], v[144:147], v[164:167], v[48:63]
    ds_read_b64_tr_b16 v[118:119], v7 offset:26176
    ds_read_b64_tr_b16 v[120:121], v6 offset:24704
    ds_read_b64_tr_b16 v[122:123], v6 offset:26240
    v_mfma_f32_32x32x16_bf16 v[64:79], v[148:151], v[164:167], v[64:79]
    ds_read_b64_tr_b16 v[124:125], v7 offset:24768
    ds_read_b64_tr_b16 v[126:127], v7 offset:26304
    ds_read_b64_tr_b16 v[128:129], v6 offset:24832
    v_mfma_f32_32x32x16_bf16 v[80:95], v[152:155], v[164:167], v[80:95]
    ds_read_b64_tr_b16 v[130:131], v6 offset:26368
    ds_read_b64_tr_b16 v[132:133], v7 offset:24896
    ds_read_b64_tr_b16 v[134:135], v7 offset:26432
    v_mfma_f32_32x32x16_bf16 v[96:111], v[156:159], v[164:167], v[96:111]
    s_waitcnt lgkmcnt(10)
    v_mfma_f32_32x32x16_bf16 v[16:31], v[112:115], v[160:163], v[16:31]
    ds_read_b128 v[164:167], v3 offset:16384
    ds_read_b64_tr_b16 v[136:137], v6 offset:30720
    ds_read_b64_tr_b16 v[138:139], v6 offset:32256
    ds_read_b64_tr_b16 v[140:141], v7 offset:30784
    s_waitcnt lgkmcnt(12)
    v_mfma_f32_32x32x16_bf16 v[32:47], v[116:119], v[160:163], v[32:47]
    ds_read_b64_tr_b16 v[142:143], v7 offset:32320
    ds_read_b64_tr_b16 v[144:145], v6 offset:30848
    ds_read_b64_tr_b16 v[146:147], v6 offset:32384
    s_waitcnt lgkmcnt(13)
    v_mfma_f32_32x32x16_bf16 v[48:63], v[120:123], v[160:163], v[48:63]
    ds_read_b64_tr_b16 v[148:149], v7 offset:30912
    ds_read_b64_tr_b16 v[150:151], v7 offset:32448
    ds_read_b64_tr_b16 v[152:153], v6 offset:30976
    s_waitcnt lgkmcnt(14)
    v_mfma_f32_32x32x16_bf16 v[64:79], v[124:127], v[160:163], v[64:79]
    ds_read_b64_tr_b16 v[154:155], v6 offset:32512
    ds_read_b64_tr_b16 v[156:157], v7 offset:31040
    ds_read_b64_tr_b16 v[158:159], v7 offset:32576
    s_waitcnt lgkmcnt(15)
    v_mfma_f32_32x32x16_bf16 v[80:95], v[128:131], v[160:163], v[80:95]
    s_waitcnt lgkmcnt(13)
    v_mfma_f32_32x32x16_bf16 v[96:111], v[132:135], v[160:163], v[96:111]
    s_waitcnt lgkmcnt(10)
    v_mfma_f32_32x32x16_bf16 v[16:31], v[136:139], v[164:167], v[16:31]
    s_waitcnt lgkmcnt(0)
    v_add_u32 v15, 1, v15
    v_mfma_f32_32x32x16_bf16 v[32:47], v[140:143], v[164:167], v[32:47]
    ds_read_b128 v[160:163], v4 offset:16384
    ds_read_b64_tr_b16 v[112:113], v6 offset:36864
    ds_read_b64_tr_b16 v[114:115], v6 offset:38400
    ds_read_b64_tr_b16 v[116:117], v7 offset:36928
    v_mfma_f32_32x32x16_bf16 v[48:63], v[144:147], v[164:167], v[48:63]
    ds_read_b64_tr_b16 v[118:119], v7 offset:38464
    ds_read_b64_tr_b16 v[120:121], v6 offset:36992
    ds_read_b64_tr_b16 v[122:123], v6 offset:38528
    v_mfma_f32_32x32x16_bf16 v[64:79], v[148:151], v[164:167], v[64:79]
    ds_read_b64_tr_b16 v[124:125], v7 offset:37056
    ds_read_b64_tr_b16 v[126:127], v7 offset:38592
    ds_read_b64_tr_b16 v[128:129], v6 offset:37120
    v_mfma_f32_32x32x16_bf16 v[80:95], v[152:155], v[164:167], v[80:95]
    ds_read_b64_tr_b16 v[130:131], v6 offset:38656
    ds_read_b64_tr_b16 v[132:133], v7 offset:37184
    ds_read_b64_tr_b16 v[134:135], v7 offset:38720
    v_mfma_f32_32x32x16_bf16 v[96:111], v[156:159], v[164:167], v[96:111]
    s_waitcnt lgkmcnt(10)
    v_mfma_f32_32x32x16_bf16 v[16:31], v[112:115], v[160:163], v[16:31]
    ds_read_b128 v[164:167], v5 offset:16384
    ds_read_b64_tr_b16 v[136:137], v6 offset:43008
    ds_read_b64_tr_b16 v[138:139], v6 offset:44544
    ds_read_b64_tr_b16 v[140:141], v7 offset:43072
    s_waitcnt lgkmcnt(12)
    v_mfma_f32_32x32x16_bf16 v[32:47], v[116:119], v[160:163], v[32:47]
    ds_read_b64_tr_b16 v[142:143], v7 offset:44608
    ds_read_b64_tr_b16 v[144:145], v6 offset:43136
    ds_read_b64_tr_b16 v[146:147], v6 offset:44672
    s_waitcnt lgkmcnt(13)
    v_mfma_f32_32x32x16_bf16 v[48:63], v[120:123], v[160:163], v[48:63]
    ds_read_b64_tr_b16 v[148:149], v7 offset:43200
    ds_read_b64_tr_b16 v[150:151], v7 offset:44736
    ds_read_b64_tr_b16 v[152:153], v6 offset:43264
    s_waitcnt lgkmcnt(14)
    v_mfma_f32_32x32x16_bf16 v[64:79], v[124:127], v[160:163], v[64:79]
    ds_read_b64_tr_b16 v[154:155], v6 offset:44800
    ds_read_b64_tr_b16 v[156:157], v7 offset:43328
    ds_read_b64_tr_b16 v[158:159], v7 offset:44864
    s_waitcnt lgkmcnt(15)
    v_mfma_f32_32x32x16_bf16 v[80:95], v[128:131], v[160:163], v[80:95]
    ds_read_b32 v12, v10
    s_waitcnt lgkmcnt(14)
    v_mfma_f32_32x32x16_bf16 v[96:111], v[132:135], v[160:163], v[96:111]
    s_waitcnt lgkmcnt(11)
    v_mfma_f32_32x32x16_bf16 v[16:31], v[136:139], v[164:167], v[16:31]
    s_waitcnt lgkmcnt(0)
    v_cmp_gt_u32 vcc, 9, v12
    v_add_u32 v15, 1, v15
    ds_write_b32 v1, v15
    v_mfma_f32_32x32x16_bf16 v[32:47], v[140:143], v[164:167], v[32:47]
    s_mov_b32 s61, 9
    s_getpc_b64 s[56:57]
    s_cbranch_vccnz common_slow
    ds_read_b128 v[160:163], v2 offset:32768
    ds_read_b64_tr_b16 v[112:113], v8 offset:0
    ds_read_b64_tr_b16 v[114:115], v8 offset:1536
    ds_read_b64_tr_b16 v[116:117], v9 offset:64
    v_mfma_f32_32x32x16_bf16 v[48:63], v[144:147], v[164:167], v[48:63]
    ds_read_b64_tr_b16 v[118:119], v9 offset:1600
    ds_read_b64_tr_b16 v[120:121], v8 offset:128
    ds_read_b64_tr_b16 v[122:123], v8 offset:1664
    v_mfma_f32_32x32x16_bf16 v[64:79], v[148:151], v[164:167], v[64:79]
    ds_read_b64_tr_b16 v[124:125], v9 offset:192
    ds_read_b64_tr_b16 v[126:127], v9 offset:1728
    ds_read_b64_tr_b16 v[128:129], v8 offset:256
    v_mfma_f32_32x32x16_bf16 v[80:95], v[152:155], v[164:167], v[80:95]
    ds_read_b64_tr_b16 v[130:131], v8 offset:1792
    ds_read_b64_tr_b16 v[132:133], v9 offset:320
    ds_read_b64_tr_b16 v[134:135], v9 offset:1856
    v_mfma_f32_32x32x16_bf16 v[96:111], v[156:159], v[164:167], v[96:111]
    s_waitcnt lgkmcnt(10)
    v_mfma_f32_32x32x16_bf16 v[16:31], v[112:115], v[160:163], v[16:31]
    ds_read_b128 v[164:167], v3 offset:32768
    ds_read_b64_tr_b16 v[136:137], v8 offset:6144
    ds_read_b64_tr_b16 v[138:139], v8 offset:7680
    ds_read_b64_tr_b16 v[140:141], v9 offset:6208
    s_waitcnt lgkmcnt(12)
    v_mfma_f32_32x32x16_bf16 v[32:47], v[116:119], v[160:163], v[32:47]
    ds_read_b64_tr_b16 v[142:143], v9 offset:7744
    ds_read_b64_tr_b16 v[144:145], v8 offset:6272
    ds_read_b64_tr_b16 v[146:147], v8 offset:7808
    s_waitcnt lgkmcnt(13)
    v_mfma_f32_32x32x16_bf16 v[48:63], v[120:123], v[160:163], v[48:63]
    ds_read_b64_tr_b16 v[148:149], v9 offset:6336
    ds_read_b64_tr_b16 v[150:151], v9 offset:7872
    ds_read_b64_tr_b16 v[152:153], v8 offset:6400
    s_waitcnt lgkmcnt(14)
    v_mfma_f32_32x32x16_bf16 v[64:79], v[124:127], v[160:163], v[64:79]
    ds_read_b64_tr_b16 v[154:155], v8 offset:7936
    ds_read_b64_tr_b16 v[156:157], v9 offset:6464
    ds_read_b64_tr_b16 v[158:159], v9 offset:8000
    s_waitcnt lgkmcnt(15)
    v_mfma_f32_32x32x16_bf16 v[80:95], v[128:131], v[160:163], v[80:95]
    s_waitcnt lgkmcnt(13)
    v_mfma_f32_32x32x16_bf16 v[96:111], v[132:135], v[160:163], v[96:111]
    s_waitcnt lgkmcnt(10)
    v_mfma_f32_32x32x16_bf16 v[16:31], v[136:139], v[164:167], v[16:31]
    s_waitcnt lgkmcnt(0)
    v_add_u32 v15, 1, v15
    v_mfma_f32_32x32x16_bf16 v[32:47], v[140:143], v[164:167], v[32:47]
    ds_read_b128 v[160:163], v4 offset:32768
    ds_read_b64_tr_b16 v[112:113], v8 offset:12288
    ds_read_b64_tr_b16 v[114:115], v8 offset:13824
    ds_read_b64_tr_b16 v[116:117], v9 offset:12352
    v_mfma_f32_32x32x16_bf16 v[48:63], v[144:147], v[164:167], v[48:63]
    ds_read_b64_tr_b16 v[118:119], v9 offset:13888
    ds_read_b64_tr_b16 v[120:121], v8 offset:12416
    ds_read_b64_tr_b16 v[122:123], v8 offset:13952
    v_mfma_f32_32x32x16_bf16 v[64:79], v[148:151], v[164:167], v[64:79]
    ds_read_b64_tr_b16 v[124:125], v9 offset:12480
    ds_read_b64_tr_b16 v[126:127], v9 offset:14016
    ds_read_b64_tr_b16 v[128:129], v8 offset:12544
    v_mfma_f32_32x32x16_bf16 v[80:95], v[152:155], v[164:167], v[80:95]
    ds_read_b64_tr_b16 v[130:131], v8 offset:14080
    ds_read_b64_tr_b16 v[132:133], v9 offset:12608
    ds_read_b64_tr_b16 v[134:135], v9 offset:14144
    v_mfma_f32_32x32x16_bf16 v[96:111], v[156:159], v[164:167], v[96:111]
    s_waitcnt lgkmcnt(10)
    v_mfma_f32_32x32x16_bf16 v[16:31], v[112:115], v[160:163], v[16:31]
    ds_read_b128 v[164:167], v5 offset:32768
    ds_read_b64_tr_b16 v[136:137], v8 offset:18432
    ds_read_b64_tr_b16 v[138:139], v8 offset:19968
    ds_read_b64_tr_b16 v[140:141], v9 offset:18496
    s_waitcnt lgkmcnt(12)
    v_mfma_f32_32x32x16_bf16 v[32:47], v[116:119], v[160:163], v[32:47]
    ds_read_b64_tr_b16 v[142:143], v9 offset:20032
    ds_read_b64_tr_b16 v[144:145], v8 offset:18560
    ds_read_b64_tr_b16 v[146:147], v8 offset:20096
    s_waitcnt lgkmcnt(13)
    v_mfma_f32_32x32x16_bf16 v[48:63], v[120:123], v[160:163], v[48:63]
    ds_read_b64_tr_b16 v[148:149], v9 offset:18624
    ds_read_b64_tr_b16 v[150:151], v9 offset:20160
    ds_read_b64_tr_b16 v[152:153], v8 offset:18688
    s_waitcnt lgkmcnt(14)
    v_mfma_f32_32x32x16_bf16 v[64:79], v[124:127], v[160:163], v[64:79]
    ds_read_b64_tr_b16 v[154:155], v8 offset:20224
    ds_read_b64_tr_b16 v[156:157], v9 offset:18752
    ds_read_b64_tr_b16 v[158:159], v9 offset:20288
    s_waitcnt lgkmcnt(15)
    v_mfma_f32_32x32x16_bf16 v[80:95], v[128:131], v[160:163], v[80:95]
    ds_read_b32 v12, v10
    s_waitcnt lgkmcnt(14)
    v_mfma_f32_32x32x16_bf16 v[96:111], v[132:135], v[160:163], v[96:111]
    s_waitcnt lgkmcnt(11)
    v_mfma_f32_32x32x16_bf16 v[16:31], v[136:139], v[164:167], v[16:31]
    s_waitcnt lgkmcnt(0)
    v_cmp_gt_u32 vcc, 12, v12
    v_add_u32 v15, 1, v15
    ds_write_b32 v1, v15
    v_mfma_f32_32x32x16_bf16 v[32:47], v[140:143], v[164:167], v[32:47]
    s_mov_b32 s61, 12
    s_getpc_b64 s[56:57]
    s_cbranch_vccnz common_slow
    ds_read_b128 v[160:163], v2 offset:49152
    ds_read_b64_tr_b16 v[112:113], v8 offset:24576
    ds_read_b64_tr_b16 v[114:115], v8 offset:26112
    ds_read_b64_tr_b16 v[116:117], v9 offset:24640
    v_mfma_f32_32x32x16_bf16 v[48:63], v[144:147], v[164:167], v[48:63]
    ds_read_b64_tr_b16 v[118:119], v9 offset:26176
    ds_read_b64_tr_b16 v[120:121], v8 offset:24704
    ds_read_b64_tr_b16 v[122:123], v8 offset:26240
    v_mfma_f32_32x32x16_bf16 v[64:79], v[148:151], v[164:167], v[64:79]
    ds_read_b64_tr_b16 v[124:125], v9 offset:24768
    ds_read_b64_tr_b16 v[126:127], v9 offset:26304
    ds_read_b64_tr_b16 v[128:129], v8 offset:24832
    v_mfma_f32_32x32x16_bf16 v[80:95], v[152:155], v[164:167], v[80:95]
    ds_read_b64_tr_b16 v[130:131], v8 offset:26368
    ds_read_b64_tr_b16 v[132:133], v9 offset:24896
    ds_read_b64_tr_b16 v[134:135], v9 offset:26432
    v_mfma_f32_32x32x16_bf16 v[96:111], v[156:159], v[164:167], v[96:111]
    s_waitcnt lgkmcnt(10)
    v_mfma_f32_32x32x16_bf16 v[16:31], v[112:115], v[160:163], v[16:31]
    ds_read_b128 v[164:167], v3 offset:49152
    ds_read_b64_tr_b16 v[136:137], v8 offset:30720
    ds_read_b64_tr_b16 v[138:139], v8 offset:32256
    ds_read_b64_tr_b16 v[140:141], v9 offset:30784
    s_waitcnt lgkmcnt(12)
    v_mfma_f32_32x32x16_bf16 v[32:47], v[116:119], v[160:163], v[32:47]
    ds_read_b64_tr_b16 v[142:143], v9 offset:32320
    ds_read_b64_tr_b16 v[144:145], v8 offset:30848
    ds_read_b64_tr_b16 v[146:147], v8 offset:32384
    s_waitcnt lgkmcnt(13)
    v_mfma_f32_32x32x16_bf16 v[48:63], v[120:123], v[160:163], v[48:63]
    ds_read_b64_tr_b16 v[148:149], v9 offset:30912
    ds_read_b64_tr_b16 v[150:151], v9 offset:32448
    ds_read_b64_tr_b16 v[152:153], v8 offset:30976
    s_waitcnt lgkmcnt(14)
    v_mfma_f32_32x32x16_bf16 v[64:79], v[124:127], v[160:163], v[64:79]
    ds_read_b64_tr_b16 v[154:155], v8 offset:32512
    ds_read_b64_tr_b16 v[156:157], v9 offset:31040
    ds_read_b64_tr_b16 v[158:159], v9 offset:32576
    s_waitcnt lgkmcnt(15)
    v_mfma_f32_32x32x16_bf16 v[80:95], v[128:131], v[160:163], v[80:95]
    s_waitcnt lgkmcnt(13)
    v_mfma_f32_32x32x16_bf16 v[96:111], v[132:135], v[160:163], v[96:111]
    s_waitcnt lgkmcnt(10)
    v_mfma_f32_32x32x16_bf16 v[16:31], v[136:139], v[164:167], v[16:31]
    s_waitcnt lgkmcnt(0)
    v_add_u32 v15, 1, v15
    v_mfma_f32_32x32x16_bf16 v[32:47], v[140:143], v[164:167], v[32:47]
    ds_read_b128 v[160:163], v4 offset:49152
    ds_read_b64_tr_b16 v[112:113], v6 offset:0
    ds_read_b64_tr_b16 v[114:115], v6 offset:1536
    ds_read_b64_tr_b16 v[116:117], v7 offset:64
    v_mfma_f32_32x32x16_bf16 v[48:63], v[144:147], v[164:167], v[48:63]
    ds_read_b64_tr_b16 v[118:119], v7 offset:1600
    ds_read_b64_tr_b16 v[120:121], v6 offset:128
    ds_read_b64_tr_b16 v[122:123], v6 offset:1664
    v_mfma_f32_32x32x16_bf16 v[64:79], v[148:151], v[164:167], v[64:79]
    ds_read_b64_tr_b16 v[124:125], v7 offset:192
    ds_read_b64_tr_b16 v[126:127], v7 offset:1728
    ds_read_b64_tr_b16 v[128:129], v6 offset:256
    v_mfma_f32_32x32x16_bf16 v[80:95], v[152:155], v[164:167], v[80:95]
    ds_read_b64_tr_b16 v[130:131], v6 offset:1792
    ds_read_b64_tr_b16 v[132:133], v7 offset:320
    ds_read_b64_tr_b16 v[134:135], v7 offset:1856
    v_mfma_f32_32x32x16_bf16 v[96:111], v[156:159], v[164:167], v[96:111]
    s_waitcnt lgkmcnt(10)
    v_mfma_f32_32x32x16_bf16 v[16:31], v[112:115], v[160:163], v[16:31]
    ds_read_b128 v[164:167], v5 offset:49152
    ds_read_b64_tr_b16 v[136:137], v6 offset:6144
    ds_read_b64_tr_b16 v[138:139], v6 offset:7680
    ds_read_b64_tr_b16 v[140:141], v7 offset:6208
    s_waitcnt lgkmcnt(12)
    v_mfma_f32_32x32x16_bf16 v[32:47], v[116:119], v[160:163], v[32:47]
    ds_read_b64_tr_b16 v[142:143], v7 offset:7744
    ds_read_b64_tr_b16 v[144:145], v6 offset:6272
    ds_read_b64_tr_b16 v[146:147], v6 offset:7808
    s_waitcnt lgkmcnt(13)
    v_mfma_f32_32x32x16_bf16 v[48:63], v[120:123], v[160:163], v[48:63]
    ds_read_b64_tr_b16 v[148:149], v7 offset:6336
    ds_read_b64_tr_b16 v[150:151], v7 offset:7872
    ds_read_b64_tr_b16 v[152:153], v6 offset:6400
    s_waitcnt lgkmcnt(14)
    v_mfma_f32_32x32x16_bf16 v[64:79], v[124:127], v[160:163], v[64:79]
    ds_read_b64_tr_b16 v[154:155], v6 offset:7936
    ds_read_b64_tr_b16 v[156:157], v7 offset:6464
    ds_read_b64_tr_b16 v[158:159], v7 offset:8000
    s_waitcnt lgkmcnt(15)
    v_mfma_f32_32x32x16_bf16 v[80:95], v[128:131], v[160:163], v[80:95]
    ds_read_b32 v12, v10
    s_waitcnt lgkmcnt(14)
    v_mfma_f32_32x32x16_bf16 v[96:111], v[132:135], v[160:163], v[96:111]
    s_waitcnt lgkmcnt(11)
    v_mfma_f32_32x32x16_bf16 v[16:31], v[136:139], v[164:167], v[16:31]
    s_waitcnt lgkmcnt(0)
    v_cmp_gt_u32 vcc, 15, v12
    v_add_u32 v15, 1, v15
    ds_write_b32 v1, v15
    v_mfma_f32_32x32x16_bf16 v[32:47], v[140:143], v[164:167], v[32:47]
    s_mov_b32 s61, 15
    s_getpc_b64 s[56:57]
    s_cbranch_vccnz common_slow
    ds_read_b128 v[160:163], v2 offset:0
    ds_read_b64_tr_b16 v[112:113], v6 offset:12288
    ds_read_b64_tr_b16 v[114:115], v6 offset:13824
    ds_read_b64_tr_b16 v[116:117], v7 offset:12352
    v_mfma_f32_32x32x16_bf16 v[48:63], v[144:147], v[164:167], v[48:63]
    ds_read_b64_tr_b16 v[118:119], v7 offset:13888
    ds_read_b64_tr_b16 v[120:121], v6 offset:12416
    ds_read_b64_tr_b16 v[122:123], v6 offset:13952
    v_mfma_f32_32x32x16_bf16 v[64:79], v[148:151], v[164:167], v[64:79]
    ds_read_b64_tr_b16 v[124:125], v7 offset:12480
    ds_read_b64_tr_b16 v[126:127], v7 offset:14016
    ds_read_b64_tr_b16 v[128:129], v6 offset:12544
    v_mfma_f32_32x32x16_bf16 v[80:95], v[152:155], v[164:167], v[80:95]
    ds_read_b64_tr_b16 v[130:131], v6 offset:14080
    ds_read_b64_tr_b16 v[132:133], v7 offset:12608
    ds_read_b64_tr_b16 v[134:135], v7 offset:14144
    v_mfma_f32_32x32x16_bf16 v[96:111], v[156:159], v[164:167], v[96:111]
    s_waitcnt lgkmcnt(10)
    v_mfma_f32_32x32x16_bf16 v[16:31], v[112:115], v[160:163], v[16:31]
    v_mov_b32 v248, 0
    buffer_load_dword v249, v248, s[36:39], 0 offen sc1
    ds_read_b128 v[164:167], v3 offset:0
    ds_read_b64_tr_b16 v[136:137], v6 offset:18432
    ds_read_b64_tr_b16 v[138:139], v6 offset:19968
    ds_read_b64_tr_b16 v[140:141], v7 offset:18496
    s_waitcnt lgkmcnt(12)
    v_mfma_f32_32x32x16_bf16 v[32:47], v[116:119], v[160:163], v[32:47]
    ds_read_b64_tr_b16 v[142:143], v7 offset:20032
    ds_read_b64_tr_b16 v[144:145], v6 offset:18560
    ds_read_b64_tr_b16 v[146:147], v6 offset:20096
    s_waitcnt lgkmcnt(13)
    v_mfma_f32_32x32x16_bf16 v[48:63], v[120:123], v[160:163], v[48:63]
    ds_read_b64_tr_b16 v[148:149], v7 offset:18624
    ds_read_b64_tr_b16 v[150:151], v7 offset:20160
    ds_read_b64_tr_b16 v[152:153], v6 offset:18688
    s_waitcnt lgkmcnt(14)
    v_mfma_f32_32x32x16_bf16 v[64:79], v[124:127], v[160:163], v[64:79]
    ds_read_b64_tr_b16 v[154:155], v6 offset:20224
    ds_read_b64_tr_b16 v[156:157], v7 offset:18752
    ds_read_b64_tr_b16 v[158:159], v7 offset:20288
    s_waitcnt lgkmcnt(15)
    v_mfma_f32_32x32x16_bf16 v[80:95], v[128:131], v[160:163], v[80:95]
    s_waitcnt lgkmcnt(13)
    v_mfma_f32_32x32x16_bf16 v[96:111], v[132:135], v[160:163], v[96:111]
    s_waitcnt lgkmcnt(10)
    v_mfma_f32_32x32x16_bf16 v[16:31], v[136:139], v[164:167], v[16:31]
    s_waitcnt lgkmcnt(0)
    v_add_u32 v15, 1, v15
    v_mfma_f32_32x32x16_bf16 v[32:47], v[140:143], v[164:167], v[32:47]
    ds_read_b128 v[160:163], v4 offset:0
    ds_read_b64_tr_b16 v[112:113], v6 offset:24576
    ds_read_b64_tr_b16 v[114:115], v6 offset:26112
    ds_read_b64_tr_b16 v[116:117], v7 offset:24640
    v_mfma_f32_32x32x16_bf16 v[48:63], v[144:147], v[164:167], v[48:63]
    ds_read_b64_tr_b16 v[118:119], v7 offset:26176
    ds_read_b64_tr_b16 v[120:121], v6 offset:24704
    ds_read_b64_tr_b16 v[122:123], v6 offset:26240
    v_mfma_f32_32x32x16_bf16 v[64:79], v[148:151], v[164:167], v[64:79]
    ds_read_b64_tr_b16 v[124:125], v7 offset:24768
    ds_read_b64_tr_b16 v[126:127], v7 offset:26304
    ds_read_b64_tr_b16 v[128:129], v6 offset:24832
    v_mfma_f32_32x32x16_bf16 v[80:95], v[152:155], v[164:167], v[80:95]
    ds_read_b64_tr_b16 v[130:131], v6 offset:26368
    ds_read_b64_tr_b16 v[132:133], v7 offset:24896
    ds_read_b64_tr_b16 v[134:135], v7 offset:26432
    v_mfma_f32_32x32x16_bf16 v[96:111], v[156:159], v[164:167], v[96:111]
    s_waitcnt lgkmcnt(10)
    v_mfma_f32_32x32x16_bf16 v[16:31], v[112:115], v[160:163], v[16:31]
    ds_read_b128 v[164:167], v5 offset:0
    ds_read_b64_tr_b16 v[136:137], v6 offset:30720
    ds_read_b64_tr_b16 v[138:139], v6 offset:32256
    ds_read_b64_tr_b16 v[140:141], v7 offset:30784
    s_waitcnt lgkmcnt(12)
    v_mfma_f32_32x32x16_bf16 v[32:47], v[116:119], v[160:163], v[32:47]
    ds_read_b64_tr_b16 v[142:143], v7 offset:32320
    ds_read_b64_tr_b16 v[144:145], v6 offset:30848
    ds_read_b64_tr_b16 v[146:147], v6 offset:32384
    s_waitcnt lgkmcnt(13)
    v_mfma_f32_32x32x16_bf16 v[48:63], v[120:123], v[160:163], v[48:63]
    ds_read_b64_tr_b16 v[148:149], v7 offset:30912
    ds_read_b64_tr_b16 v[150:151], v7 offset:32448
    ds_read_b64_tr_b16 v[152:153], v6 offset:30976
    s_waitcnt lgkmcnt(14)
    v_mfma_f32_32x32x16_bf16 v[64:79], v[124:127], v[160:163], v[64:79]
    ds_read_b64_tr_b16 v[154:155], v6 offset:32512
    ds_read_b64_tr_b16 v[156:157], v7 offset:31040
    ds_read_b64_tr_b16 v[158:159], v7 offset:32576
    s_waitcnt lgkmcnt(15)
    v_mfma_f32_32x32x16_bf16 v[80:95], v[128:131], v[160:163], v[80:95]
    ds_read_b32 v12, v10
    s_waitcnt lgkmcnt(14)
    v_mfma_f32_32x32x16_bf16 v[96:111], v[132:135], v[160:163], v[96:111]
    s_waitcnt lgkmcnt(11)
    v_mfma_f32_32x32x16_bf16 v[16:31], v[136:139], v[164:167], v[16:31]
    s_waitcnt lgkmcnt(0)
    v_cmp_gt_u32 vcc, 18, v12
    v_add_u32 v15, 1, v15
    ds_write_b32 v1, v15
    v_mfma_f32_32x32x16_bf16 v[32:47], v[140:143], v[164:167], v[32:47]
    s_mov_b32 s61, 18
    s_getpc_b64 s[56:57]
    s_cbranch_vccnz common_slow
    ds_read_b128 v[160:163], v2 offset:16384
    ds_read_b64_tr_b16 v[112:113], v6 offset:36864
    ds_read_b64_tr_b16 v[114:115], v6 offset:38400
    ds_read_b64_tr_b16 v[116:117], v7 offset:36928
    v_mfma_f32_32x32x16_bf16 v[48:63], v[144:147], v[164:167], v[48:63]
    ds_read_b64_tr_b16 v[118:119], v7 offset:38464
    ds_read_b64_tr_b16 v[120:121], v6 offset:36992
    ds_read_b64_tr_b16 v[122:123], v6 offset:38528
    v_mfma_f32_32x32x16_bf16 v[64:79], v[148:151], v[164:167], v[64:79]
    ds_read_b64_tr_b16 v[124:125], v7 offset:37056
    ds_read_b64_tr_b16 v[126:127], v7 offset:38592
    ds_read_b64_tr_b16 v[128:129], v6 offset:37120
    v_mfma_f32_32x32x16_bf16 v[80:95], v[152:155], v[164:167], v[80:95]
    ds_read_b64_tr_b16 v[130:131], v6 offset:38656
    ds_read_b64_tr_b16 v[132:133], v7 offset:37184
    ds_read_b64_tr_b16 v[134:135], v7 offset:38720
    v_mfma_f32_32x32x16_bf16 v[96:111], v[156:159], v[164:167], v[96:111]
    s_waitcnt lgkmcnt(10)
    v_mfma_f32_32x32x16_bf16 v[16:31], v[112:115], v[160:163], v[16:31]
    ds_read_b128 v[164:167], v3 offset:16384
    ds_read_b64_tr_b16 v[136:137], v6 offset:43008
    ds_read_b64_tr_b16 v[138:139], v6 offset:44544
    ds_read_b64_tr_b16 v[140:141], v7 offset:43072
    s_waitcnt lgkmcnt(12)
    v_mfma_f32_32x32x16_bf16 v[32:47], v[116:119], v[160:163], v[32:47]
    ds_read_b64_tr_b16 v[142:143], v7 offset:44608
    ds_read_b64_tr_b16 v[144:145], v6 offset:43136
    ds_read_b64_tr_b16 v[146:147], v6 offset:44672
    s_waitcnt lgkmcnt(13)
    v_mfma_f32_32x32x16_bf16 v[48:63], v[120:123], v[160:163], v[48:63]
    ds_read_b64_tr_b16 v[148:149], v7 offset:43200
    ds_read_b64_tr_b16 v[150:151], v7 offset:44736
    ds_read_b64_tr_b16 v[152:153], v6 offset:43264
    s_waitcnt lgkmcnt(14)
    v_mfma_f32_32x32x16_bf16 v[64:79], v[124:127], v[160:163], v[64:79]
    ds_read_b64_tr_b16 v[154:155], v6 offset:44800
    ds_read_b64_tr_b16 v[156:157], v7 offset:43328
    ds_read_b64_tr_b16 v[158:159], v7 offset:44864
    s_waitcnt lgkmcnt(15)
    v_mfma_f32_32x32x16_bf16 v[80:95], v[128:131], v[160:163], v[80:95]
    s_waitcnt lgkmcnt(13)
    v_mfma_f32_32x32x16_bf16 v[96:111], v[132:135], v[160:163], v[96:111]
    s_waitcnt lgkmcnt(10)
    v_mfma_f32_32x32x16_bf16 v[16:31], v[136:139], v[164:167], v[16:31]
    s_waitcnt lgkmcnt(0)
    v_add_u32 v15, 1, v15
    v_mfma_f32_32x32x16_bf16 v[32:47], v[140:143], v[164:167], v[32:47]
    ds_read_b128 v[160:163], v4 offset:16384
    ds_read_b64_tr_b16 v[112:113], v8 offset:0
    ds_read_b64_tr_b16 v[114:115], v8 offset:1536
    ds_read_b64_tr_b16 v[116:117], v9 offset:64
    v_mfma_f32_32x32x16_bf16 v[48:63], v[144:147], v[164:167], v[48:63]
    ds_read_b64_tr_b16 v[118:119], v9 offset:1600
    ds_read_b64_tr_b16 v[120:121], v8 offset:128
    ds_read_b64_tr_b16 v[122:123], v8 offset:1664
    v_mfma_f32_32x32x16_bf16 v[64:79], v[148:151], v[164:167], v[64:79]
    ds_read_b64_tr_b16 v[124:125], v9 offset:192
    ds_read_b64_tr_b16 v[126:127], v9 offset:1728
    ds_read_b64_tr_b16 v[128:129], v8 offset:256
    v_mfma_f32_32x32x16_bf16 v[80:95], v[152:155], v[164:167], v[80:95]
    ds_read_b64_tr_b16 v[130:131], v8 offset:1792
    ds_read_b64_tr_b16 v[132:133], v9 offset:320
    ds_read_b64_tr_b16 v[134:135], v9 offset:1856
    v_mfma_f32_32x32x16_bf16 v[96:111], v[156:159], v[164:167], v[96:111]
    s_waitcnt lgkmcnt(10)
    v_mfma_f32_32x32x16_bf16 v[16:31], v[112:115], v[160:163], v[16:31]
    ds_read_b128 v[164:167], v5 offset:16384
    ds_read_b64_tr_b16 v[136:137], v8 offset:6144
    ds_read_b64_tr_b16 v[138:139], v8 offset:7680
    ds_read_b64_tr_b16 v[140:141], v9 offset:6208
    s_waitcnt lgkmcnt(12)
    v_mfma_f32_32x32x16_bf16 v[32:47], v[116:119], v[160:163], v[32:47]
    ds_read_b64_tr_b16 v[142:143], v9 offset:7744
    ds_read_b64_tr_b16 v[144:145], v8 offset:6272
    ds_read_b64_tr_b16 v[146:147], v8 offset:7808
    s_waitcnt lgkmcnt(13)
    v_mfma_f32_32x32x16_bf16 v[48:63], v[120:123], v[160:163], v[48:63]
    ds_read_b64_tr_b16 v[148:149], v9 offset:6336
    ds_read_b64_tr_b16 v[150:151], v9 offset:7872
    ds_read_b64_tr_b16 v[152:153], v8 offset:6400
    s_waitcnt lgkmcnt(14)
    v_mfma_f32_32x32x16_bf16 v[64:79], v[124:127], v[160:163], v[64:79]
    ds_read_b64_tr_b16 v[154:155], v8 offset:7936
    ds_read_b64_tr_b16 v[156:157], v9 offset:6464
    ds_read_b64_tr_b16 v[158:159], v9 offset:8000
    s_waitcnt lgkmcnt(15)
    v_mfma_f32_32x32x16_bf16 v[80:95], v[128:131], v[160:163], v[80:95]
    ds_read_b32 v12, v10
    s_waitcnt lgkmcnt(14)
    v_mfma_f32_32x32x16_bf16 v[96:111], v[132:135], v[160:163], v[96:111]
    s_waitcnt lgkmcnt(11)
    v_mfma_f32_32x32x16_bf16 v[16:31], v[136:139], v[164:167], v[16:31]
    s_waitcnt lgkmcnt(0)
    v_cmp_gt_u32 vcc, 21, v12
    v_add_u32 v15, 1, v15
    ds_write_b32 v1, v15
    v_mfma_f32_32x32x16_bf16 v[32:47], v[140:143], v[164:167], v[32:47]
    s_mov_b32 s61, 21
    s_getpc_b64 s[56:57]
    s_cbranch_vccnz common_slow
    ds_read_b128 v[160:163], v2 offset:32768
    ds_read_b64_tr_b16 v[112:113], v8 offset:12288
    ds_read_b64_tr_b16 v[114:115], v8 offset:13824
    ds_read_b64_tr_b16 v[116:117], v9 offset:12352
    v_mfma_f32_32x32x16_bf16 v[48:63], v[144:147], v[164:167], v[48:63]
    ds_read_b64_tr_b16 v[118:119], v9 offset:13888
    ds_read_b64_tr_b16 v[120:121], v8 offset:12416
    ds_read_b64_tr_b16 v[122:123], v8 offset:13952
    v_mfma_f32_32x32x16_bf16 v[64:79], v[148:151], v[164:167], v[64:79]
    ds_read_b64_tr_b16 v[124:125], v9 offset:12480
    ds_read_b64_tr_b16 v[126:127], v9 offset:14016
    ds_read_b64_tr_b16 v[128:129], v8 offset:12544
    v_mfma_f32_32x32x16_bf16 v[80:95], v[152:155], v[164:167], v[80:95]
    ds_read_b64_tr_b16 v[130:131], v8 offset:14080
    ds_read_b64_tr_b16 v[132:133], v9 offset:12608
    ds_read_b64_tr_b16 v[134:135], v9 offset:14144
    v_mfma_f32_32x32x16_bf16 v[96:111], v[156:159], v[164:167], v[96:111]
    s_waitcnt lgkmcnt(10)
    v_mfma_f32_32x32x16_bf16 v[16:31], v[112:115], v[160:163], v[16:31]
    ds_read_b128 v[164:167], v3 offset:32768
    ds_read_b64_tr_b16 v[136:137], v8 offset:18432
    ds_read_b64_tr_b16 v[138:139], v8 offset:19968
    ds_read_b64_tr_b16 v[140:141], v9 offset:18496
    s_waitcnt lgkmcnt(12)
    v_mfma_f32_32x32x16_bf16 v[32:47], v[116:119], v[160:163], v[32:47]
    ds_read_b64_tr_b16 v[142:143], v9 offset:20032
    ds_read_b64_tr_b16 v[144:145], v8 offset:18560
    ds_read_b64_tr_b16 v[146:147], v8 offset:20096
    s_waitcnt lgkmcnt(13)
    v_mfma_f32_32x32x16_bf16 v[48:63], v[120:123], v[160:163], v[48:63]
    ds_read_b64_tr_b16 v[148:149], v9 offset:18624
    ds_read_b64_tr_b16 v[150:151], v9 offset:20160
    ds_read_b64_tr_b16 v[152:153], v8 offset:18688
    s_waitcnt lgkmcnt(14)
    v_mfma_f32_32x32x16_bf16 v[64:79], v[124:127], v[160:163], v[64:79]
    ds_read_b64_tr_b16 v[154:155], v8 offset:20224
    ds_read_b64_tr_b16 v[156:157], v9 offset:18752
    ds_read_b64_tr_b16 v[158:159], v9 offset:20288
    s_waitcnt lgkmcnt(15)
    v_mfma_f32_32x32x16_bf16 v[80:95], v[128:131], v[160:163], v[80:95]
    s_waitcnt lgkmcnt(13)
    v_mfma_f32_32x32x16_bf16 v[96:111], v[132:135], v[160:163], v[96:111]
    s_waitcnt lgkmcnt(10)
    v_mfma_f32_32x32x16_bf16 v[16:31], v[136:139], v[164:167], v[16:31]
    s_waitcnt lgkmcnt(0)
    v_add_u32 v15, 1, v15
    v_mfma_f32_32x32x16_bf16 v[32:47], v[140:143], v[164:167], v[32:47]
    ds_read_b128 v[160:163], v4 offset:32768
    ds_read_b64_tr_b16 v[112:113], v8 offset:24576
    ds_read_b64_tr_b16 v[114:115], v8 offset:26112
    ds_read_b64_tr_b16 v[116:117], v9 offset:24640
    v_mfma_f32_32x32x16_bf16 v[48:63], v[144:147], v[164:167], v[48:63]
    ds_read_b64_tr_b16 v[118:119], v9 offset:26176
    ds_read_b64_tr_b16 v[120:121], v8 offset:24704
    ds_read_b64_tr_b16 v[122:123], v8 offset:26240
    v_mfma_f32_32x32x16_bf16 v[64:79], v[148:151], v[164:167], v[64:79]
    ds_read_b64_tr_b16 v[124:125], v9 offset:24768
    ds_read_b64_tr_b16 v[126:127], v9 offset:26304
    ds_read_b64_tr_b16 v[128:129], v8 offset:24832
    v_mfma_f32_32x32x16_bf16 v[80:95], v[152:155], v[164:167], v[80:95]
    ds_read_b64_tr_b16 v[130:131], v8 offset:26368
    ds_read_b64_tr_b16 v[132:133], v9 offset:24896
    ds_read_b64_tr_b16 v[134:135], v9 offset:26432
    v_mfma_f32_32x32x16_bf16 v[96:111], v[156:159], v[164:167], v[96:111]
    s_waitcnt lgkmcnt(10)
    v_mfma_f32_32x32x16_bf16 v[16:31], v[112:115], v[160:163], v[16:31]
    ds_read_b128 v[164:167], v5 offset:32768
    ds_read_b64_tr_b16 v[136:137], v8 offset:30720
    ds_read_b64_tr_b16 v[138:139], v8 offset:32256
    ds_read_b64_tr_b16 v[140:141], v9 offset:30784
    s_waitcnt lgkmcnt(12)
    v_mfma_f32_32x32x16_bf16 v[32:47], v[116:119], v[160:163], v[32:47]
    ds_read_b64_tr_b16 v[142:143], v9 offset:32320
    ds_read_b64_tr_b16 v[144:145], v8 offset:30848
    ds_read_b64_tr_b16 v[146:147], v8 offset:32384
    s_waitcnt lgkmcnt(13)
    v_mfma_f32_32x32x16_bf16 v[48:63], v[120:123], v[160:163], v[48:63]
    ds_read_b64_tr_b16 v[148:149], v9 offset:30912
    ds_read_b64_tr_b16 v[150:151], v9 offset:32448
    ds_read_b64_tr_b16 v[152:153], v8 offset:30976
    s_waitcnt lgkmcnt(14)
    v_mfma_f32_32x32x16_bf16 v[64:79], v[124:127], v[160:163], v[64:79]
    ds_read_b64_tr_b16 v[154:155], v8 offset:32512
    ds_read_b64_tr_b16 v[156:157], v9 offset:31040
    ds_read_b64_tr_b16 v[158:159], v9 offset:32576
    s_waitcnt lgkmcnt(15)
    v_mfma_f32_32x32x16_bf16 v[80:95], v[128:131], v[160:163], v[80:95]
    ds_read_b32 v12, v10
    s_waitcnt lgkmcnt(14)
    v_mfma_f32_32x32x16_bf16 v[96:111], v[132:135], v[160:163], v[96:111]
    s_waitcnt lgkmcnt(11)
    v_mfma_f32_32x32x16_bf16 v[16:31], v[136:139], v[164:167], v[16:31]
    s_waitcnt lgkmcnt(0)
    v_cmp_gt_u32 vcc, 24, v12
    v_add_u32 v15, 1, v15
    ds_write_b32 v1, v15
    v_mfma_f32_32x32x16_bf16 v[32:47], v[140:143], v[164:167], v[32:47]
    s_mov_b32 s61, 24
    s_getpc_b64 s[56:57]
    s_cbranch_vccnz common_slow
    ds_read_b128 v[160:163], v2 offset:49152
    ds_read_b64_tr_b16 v[112:113], v6 offset:0
    ds_read_b64_tr_b16 v[114:115], v6 offset:1536
    ds_read_b64_tr_b16 v[116:117], v7 offset:64
    v_mfma_f32_32x32x16_bf16 v[48:63], v[144:147], v[164:167], v[48:63]
    ds_read_b64_tr_b16 v[118:119], v7 offset:1600
    ds_read_b64_tr_b16 v[120:121], v6 offset:128
    ds_read_b64_tr_b16 v[122:123], v6 offset:1664
    v_mfma_f32_32x32x16_bf16 v[64:79], v[148:151], v[164:167], v[64:79]
    ds_read_b64_tr_b16 v[124:125], v7 offset:192
    ds_read_b64_tr_b16 v[126:127], v7 offset:1728
    ds_read_b64_tr_b16 v[128:129], v6 offset:256
    v_mfma_f32_32x32x16_bf16 v[80:95], v[152:155], v[164:167], v[80:95]
    ds_read_b64_tr_b16 v[130:131], v6 offset:1792
    ds_read_b64_tr_b16 v[132:133], v7 offset:320
    ds_read_b64_tr_b16 v[134:135], v7 offset:1856
    v_mfma_f32_32x32x16_bf16 v[96:111], v[156:159], v[164:167], v[96:111]
    s_waitcnt lgkmcnt(10)
    v_mfma_f32_32x32x16_bf16 v[16:31], v[112:115], v[160:163], v[16:31]
    ds_read_b128 v[164:167], v3 offset:49152
    ds_read_b64_tr_b16 v[136:137], v6 offset:6144
    ds_read_b64_tr_b16 v[138:139], v6 offset:7680
    ds_read_b64_tr_b16 v[140:141], v7 offset:6208
    s_waitcnt lgkmcnt(12)
    v_mfma_f32_32x32x16_bf16 v[32:47], v[116:119], v[160:163], v[32:47]
    ds_read_b64_tr_b16 v[142:143], v7 offset:7744
    ds_read_b64_tr_b16 v[144:145], v6 offset:6272
    ds_read_b64_tr_b16 v[146:147], v6 offset:7808
    s_waitcnt lgkmcnt(13)
    v_mfma_f32_32x32x16_bf16 v[48:63], v[120:123], v[160:163], v[48:63]
    ds_read_b64_tr_b16 v[148:149], v7 offset:6336
    ds_read_b64_tr_b16 v[150:151], v7 offset:7872
    ds_read_b64_tr_b16 v[152:153], v6 offset:6400
    s_waitcnt lgkmcnt(14)
    v_mfma_f32_32x32x16_bf16 v[64:79], v[124:127], v[160:163], v[64:79]
    ds_read_b64_tr_b16 v[154:155], v6 offset:7936
    ds_read_b64_tr_b16 v[156:157], v7 offset:6464
    ds_read_b64_tr_b16 v[158:159], v7 offset:8000
    s_waitcnt lgkmcnt(15)
    v_mfma_f32_32x32x16_bf16 v[80:95], v[128:131], v[160:163], v[80:95]
    s_waitcnt lgkmcnt(13)
    v_mfma_f32_32x32x16_bf16 v[96:111], v[132:135], v[160:163], v[96:111]
    s_waitcnt lgkmcnt(10)
    v_mfma_f32_32x32x16_bf16 v[16:31], v[136:139], v[164:167], v[16:31]
    s_waitcnt lgkmcnt(0)
    v_add_u32 v15, 1, v15
    v_mfma_f32_32x32x16_bf16 v[32:47], v[140:143], v[164:167], v[32:47]
    ds_read_b128 v[160:163], v4 offset:49152
    ds_read_b64_tr_b16 v[112:113], v6 offset:12288
    ds_read_b64_tr_b16 v[114:115], v6 offset:13824
    ds_read_b64_tr_b16 v[116:117], v7 offset:12352
    v_mfma_f32_32x32x16_bf16 v[48:63], v[144:147], v[164:167], v[48:63]
    ds_read_b64_tr_b16 v[118:119], v7 offset:13888
    ds_read_b64_tr_b16 v[120:121], v6 offset:12416
    ds_read_b64_tr_b16 v[122:123], v6 offset:13952
    v_mfma_f32_32x32x16_bf16 v[64:79], v[148:151], v[164:167], v[64:79]
    ds_read_b64_tr_b16 v[124:125], v7 offset:12480
    ds_read_b64_tr_b16 v[126:127], v7 offset:14016
    ds_read_b64_tr_b16 v[128:129], v6 offset:12544
    v_mfma_f32_32x32x16_bf16 v[80:95], v[152:155], v[164:167], v[80:95]
    ds_read_b64_tr_b16 v[130:131], v6 offset:14080
    ds_read_b64_tr_b16 v[132:133], v7 offset:12608
    ds_read_b64_tr_b16 v[134:135], v7 offset:14144
    v_mfma_f32_32x32x16_bf16 v[96:111], v[156:159], v[164:167], v[96:111]
    s_waitcnt lgkmcnt(10)
    v_mfma_f32_32x32x16_bf16 v[16:31], v[112:115], v[160:163], v[16:31]
    ds_read_b128 v[164:167], v5 offset:49152
    ds_read_b64_tr_b16 v[136:137], v6 offset:18432
    ds_read_b64_tr_b16 v[138:139], v6 offset:19968
    ds_read_b64_tr_b16 v[140:141], v7 offset:18496
    s_waitcnt lgkmcnt(12)
    v_mfma_f32_32x32x16_bf16 v[32:47], v[116:119], v[160:163], v[32:47]
    ds_read_b64_tr_b16 v[142:143], v7 offset:20032
    ds_read_b64_tr_b16 v[144:145], v6 offset:18560
    ds_read_b64_tr_b16 v[146:147], v6 offset:20096
    s_waitcnt lgkmcnt(13)
    v_mfma_f32_32x32x16_bf16 v[48:63], v[120:123], v[160:163], v[48:63]
    ds_read_b64_tr_b16 v[148:149], v7 offset:18624
    ds_read_b64_tr_b16 v[150:151], v7 offset:20160
    ds_read_b64_tr_b16 v[152:153], v6 offset:18688
    s_waitcnt lgkmcnt(14)
    v_mfma_f32_32x32x16_bf16 v[64:79], v[124:127], v[160:163], v[64:79]
    ds_read_b64_tr_b16 v[154:155], v6 offset:20224
    ds_read_b64_tr_b16 v[156:157], v7 offset:18752
    ds_read_b64_tr_b16 v[158:159], v7 offset:20288
    s_waitcnt lgkmcnt(15)
    v_mfma_f32_32x32x16_bf16 v[80:95], v[128:131], v[160:163], v[80:95]
    ds_read_b32 v12, v10
    s_waitcnt lgkmcnt(14)
    v_mfma_f32_32x32x16_bf16 v[96:111], v[132:135], v[160:163], v[96:111]
    s_waitcnt lgkmcnt(11)
    v_mfma_f32_32x32x16_bf16 v[16:31], v[136:139], v[164:167], v[16:31]
    s_waitcnt lgkmcnt(0)
    v_cmp_gt_u32 vcc, 27, v12
    v_add_u32 v15, 1, v15
    ds_write_b32 v1, v15
    v_mfma_f32_32x32x16_bf16 v[32:47], v[140:143], v[164:167], v[32:47]
    s_mov_b32 s61, 27
    s_getpc_b64 s[56:57]
    s_cbranch_vccnz common_slow
    ds_read_b128 v[160:163], v2 offset:0
    ds_read_b64_tr_b16 v[112:113], v6 offset:24576
    ds_read_b64_tr_b16 v[114:115], v6 offset:26112
    ds_read_b64_tr_b16 v[116:117], v7 offset:24640
    v_mfma_f32_32x32x16_bf16 v[48:63], v[144:147], v[164:167], v[48:63]
    ds_read_b64_tr_b16 v[118:119], v7 offset:26176
    ds_read_b64_tr_b16 v[120:121], v6 offset:24704
    ds_read_b64_tr_b16 v[122:123], v6 offset:26240
    v_mfma_f32_32x32x16_bf16 v[64:79], v[148:151], v[164:167], v[64:79]
    ds_read_b64_tr_b16 v[124:125], v7 offset:24768
    ds_read_b64_tr_b16 v[126:127], v7 offset:26304
    ds_read_b64_tr_b16 v[128:129], v6 offset:24832
    v_mfma_f32_32x32x16_bf16 v[80:95], v[152:155], v[164:167], v[80:95]
    ds_read_b64_tr_b16 v[130:131], v6 offset:26368
    ds_read_b64_tr_b16 v[132:133], v7 offset:24896
    ds_read_b64_tr_b16 v[134:135], v7 offset:26432
    v_mfma_f32_32x32x16_bf16 v[96:111], v[156:159], v[164:167], v[96:111]
    s_waitcnt lgkmcnt(10)
    v_mfma_f32_32x32x16_bf16 v[16:31], v[112:115], v[160:163], v[16:31]
    ds_read_b128 v[164:167], v3 offset:0
    ds_read_b64_tr_b16 v[136:137], v6 offset:30720
    ds_read_b64_tr_b16 v[138:139], v6 offset:32256
    ds_read_b64_tr_b16 v[140:141], v7 offset:30784
    s_waitcnt lgkmcnt(12)
    v_mfma_f32_32x32x16_bf16 v[32:47], v[116:119], v[160:163], v[32:47]
    ds_read_b64_tr_b16 v[142:143], v7 offset:32320
    ds_read_b64_tr_b16 v[144:145], v6 offset:30848
    ds_read_b64_tr_b16 v[146:147], v6 offset:32384
    s_waitcnt lgkmcnt(13)
    v_mfma_f32_32x32x16_bf16 v[48:63], v[120:123], v[160:163], v[48:63]
    ds_read_b64_tr_b16 v[148:149], v7 offset:30912
    ds_read_b64_tr_b16 v[150:151], v7 offset:32448
    ds_read_b64_tr_b16 v[152:153], v6 offset:30976
    s_waitcnt lgkmcnt(14)
    v_mfma_f32_32x32x16_bf16 v[64:79], v[124:127], v[160:163], v[64:79]
    ds_read_b64_tr_b16 v[154:155], v6 offset:32512
    ds_read_b64_tr_b16 v[156:157], v7 offset:31040
    ds_read_b64_tr_b16 v[158:159], v7 offset:32576
    s_waitcnt lgkmcnt(15)
    v_mfma_f32_32x32x16_bf16 v[80:95], v[128:131], v[160:163], v[80:95]
    s_waitcnt lgkmcnt(13)
    v_mfma_f32_32x32x16_bf16 v[96:111], v[132:135], v[160:163], v[96:111]
    s_waitcnt lgkmcnt(10)
    v_mfma_f32_32x32x16_bf16 v[16:31], v[136:139], v[164:167], v[16:31]
    s_waitcnt lgkmcnt(0)
    v_add_u32 v15, 1, v15
    v_mfma_f32_32x32x16_bf16 v[32:47], v[140:143], v[164:167], v[32:47]
    ds_read_b128 v[160:163], v4 offset:0
    ds_read_b64_tr_b16 v[112:113], v6 offset:36864
    ds_read_b64_tr_b16 v[114:115], v6 offset:38400
    ds_read_b64_tr_b16 v[116:117], v7 offset:36928
    v_mfma_f32_32x32x16_bf16 v[48:63], v[144:147], v[164:167], v[48:63]
    ds_read_b64_tr_b16 v[118:119], v7 offset:38464
    ds_read_b64_tr_b16 v[120:121], v6 offset:36992
    ds_read_b64_tr_b16 v[122:123], v6 offset:38528
    v_mfma_f32_32x32x16_bf16 v[64:79], v[148:151], v[164:167], v[64:79]
    ds_read_b64_tr_b16 v[124:125], v7 offset:37056
    ds_read_b64_tr_b16 v[126:127], v7 offset:38592
    ds_read_b64_tr_b16 v[128:129], v6 offset:37120
    v_mfma_f32_32x32x16_bf16 v[80:95], v[152:155], v[164:167], v[80:95]
    ds_read_b64_tr_b16 v[130:131], v6 offset:38656
    ds_read_b64_tr_b16 v[132:133], v7 offset:37184
    ds_read_b64_tr_b16 v[134:135], v7 offset:38720
    v_mfma_f32_32x32x16_bf16 v[96:111], v[156:159], v[164:167], v[96:111]
    s_waitcnt lgkmcnt(10)
    v_mfma_f32_32x32x16_bf16 v[16:31], v[112:115], v[160:163], v[16:31]
    ds_read_b128 v[164:167], v5 offset:0
    ds_read_b64_tr_b16 v[136:137], v6 offset:43008
    ds_read_b64_tr_b16 v[138:139], v6 offset:44544
    ds_read_b64_tr_b16 v[140:141], v7 offset:43072
    s_waitcnt lgkmcnt(12)
    v_mfma_f32_32x32x16_bf16 v[32:47], v[116:119], v[160:163], v[32:47]
    ds_read_b64_tr_b16 v[142:143], v7 offset:44608
    ds_read_b64_tr_b16 v[144:145], v6 offset:43136
    ds_read_b64_tr_b16 v[146:147], v6 offset:44672
    s_waitcnt lgkmcnt(13)
    v_mfma_f32_32x32x16_bf16 v[48:63], v[120:123], v[160:163], v[48:63]
    ds_read_b64_tr_b16 v[148:149], v7 offset:43200
    ds_read_b64_tr_b16 v[150:151], v7 offset:44736
    ds_read_b64_tr_b16 v[152:153], v6 offset:43264
    s_waitcnt lgkmcnt(14)
    v_mfma_f32_32x32x16_bf16 v[64:79], v[124:127], v[160:163], v[64:79]
    ds_read_b64_tr_b16 v[154:155], v6 offset:44800
    ds_read_b64_tr_b16 v[156:157], v7 offset:43328
    ds_read_b64_tr_b16 v[158:159], v7 offset:44864
    s_waitcnt lgkmcnt(15)
    v_mfma_f32_32x32x16_bf16 v[80:95], v[128:131], v[160:163], v[80:95]
    ds_read_b32 v12, v10
    s_waitcnt lgkmcnt(14)
    v_mfma_f32_32x32x16_bf16 v[96:111], v[132:135], v[160:163], v[96:111]
    s_waitcnt lgkmcnt(11)
    v_mfma_f32_32x32x16_bf16 v[16:31], v[136:139], v[164:167], v[16:31]
    s_waitcnt lgkmcnt(0)
    v_cmp_gt_u32 vcc, 30, v12
    v_add_u32 v15, 1, v15
    ds_write_b32 v1, v15
    v_mfma_f32_32x32x16_bf16 v[32:47], v[140:143], v[164:167], v[32:47]
    s_mov_b32 s61, 30
    s_getpc_b64 s[56:57]
    s_cbranch_vccnz common_slow
    ds_read_b128 v[160:163], v2 offset:16384
    ds_read_b64_tr_b16 v[112:113], v8 offset:0
    ds_read_b64_tr_b16 v[114:115], v8 offset:1536
    ds_read_b64_tr_b16 v[116:117], v9 offset:64
    v_mfma_f32_32x32x16_bf16 v[48:63], v[144:147], v[164:167], v[48:63]
    ds_read_b64_tr_b16 v[118:119], v9 offset:1600
    ds_read_b64_tr_b16 v[120:121], v8 offset:128
    ds_read_b64_tr_b16 v[122:123], v8 offset:1664
    v_mfma_f32_32x32x16_bf16 v[64:79], v[148:151], v[164:167], v[64:79]
    ds_read_b64_tr_b16 v[124:125], v9 offset:192
    ds_read_b64_tr_b16 v[126:127], v9 offset:1728
    ds_read_b64_tr_b16 v[128:129], v8 offset:256
    v_mfma_f32_32x32x16_bf16 v[80:95], v[152:155], v[164:167], v[80:95]
    ds_read_b64_tr_b16 v[130:131], v8 offset:1792
    ds_read_b64_tr_b16 v[132:133], v9 offset:320
    ds_read_b64_tr_b16 v[134:135], v9 offset:1856
    v_mfma_f32_32x32x16_bf16 v[96:111], v[156:159], v[164:167], v[96:111]
    s_waitcnt lgkmcnt(10)
    v_mfma_f32_32x32x16_bf16 v[16:31], v[112:115], v[160:163], v[16:31]
    ds_read_b128 v[164:167], v3 offset:16384
    ds_read_b64_tr_b16 v[136:137], v8 offset:6144
    ds_read_b64_tr_b16 v[138:139], v8 offset:7680
    ds_read_b64_tr_b16 v[140:141], v9 offset:6208
    s_waitcnt lgkmcnt(12)
    v_mfma_f32_32x32x16_bf16 v[32:47], v[116:119], v[160:163], v[32:47]
    ds_read_b64_tr_b16 v[142:143], v9 offset:7744
    ds_read_b64_tr_b16 v[144:145], v8 offset:6272
    ds_read_b64_tr_b16 v[146:147], v8 offset:7808
    s_waitcnt lgkmcnt(13)
    v_mfma_f32_32x32x16_bf16 v[48:63], v[120:123], v[160:163], v[48:63]
    ds_read_b64_tr_b16 v[148:149], v9 offset:6336
    ds_read_b64_tr_b16 v[150:151], v9 offset:7872
    ds_read_b64_tr_b16 v[152:153], v8 offset:6400
    s_waitcnt lgkmcnt(14)
    v_mfma_f32_32x32x16_bf16 v[64:79], v[124:127], v[160:163], v[64:79]
    ds_read_b64_tr_b16 v[154:155], v8 offset:7936
    ds_read_b64_tr_b16 v[156:157], v9 offset:6464
    ds_read_b64_tr_b16 v[158:159], v9 offset:8000
    s_waitcnt lgkmcnt(15)
    v_mfma_f32_32x32x16_bf16 v[80:95], v[128:131], v[160:163], v[80:95]
    s_waitcnt lgkmcnt(13)
    v_mfma_f32_32x32x16_bf16 v[96:111], v[132:135], v[160:163], v[96:111]
    s_waitcnt lgkmcnt(10)
    v_mfma_f32_32x32x16_bf16 v[16:31], v[136:139], v[164:167], v[16:31]
    s_waitcnt lgkmcnt(0)
    v_add_u32 v15, 1, v15
    v_mfma_f32_32x32x16_bf16 v[32:47], v[140:143], v[164:167], v[32:47]
    ds_read_b128 v[160:163], v4 offset:16384
    ds_read_b64_tr_b16 v[112:113], v8 offset:12288
    ds_read_b64_tr_b16 v[114:115], v8 offset:13824
    ds_read_b64_tr_b16 v[116:117], v9 offset:12352
    v_mfma_f32_32x32x16_bf16 v[48:63], v[144:147], v[164:167], v[48:63]
    ds_read_b64_tr_b16 v[118:119], v9 offset:13888
    ds_read_b64_tr_b16 v[120:121], v8 offset:12416
    ds_read_b64_tr_b16 v[122:123], v8 offset:13952
    v_mfma_f32_32x32x16_bf16 v[64:79], v[148:151], v[164:167], v[64:79]
    ds_read_b64_tr_b16 v[124:125], v9 offset:12480
    ds_read_b64_tr_b16 v[126:127], v9 offset:14016
    ds_read_b64_tr_b16 v[128:129], v8 offset:12544
    v_mfma_f32_32x32x16_bf16 v[80:95], v[152:155], v[164:167], v[80:95]
    ds_read_b64_tr_b16 v[130:131], v8 offset:14080
    ds_read_b64_tr_b16 v[132:133], v9 offset:12608
    ds_read_b64_tr_b16 v[134:135], v9 offset:14144
    v_mfma_f32_32x32x16_bf16 v[96:111], v[156:159], v[164:167], v[96:111]
    s_waitcnt lgkmcnt(10)
    v_mfma_f32_32x32x16_bf16 v[16:31], v[112:115], v[160:163], v[16:31]
    ds_read_b128 v[164:167], v5 offset:16384
    ds_read_b64_tr_b16 v[136:137], v8 offset:18432
    ds_read_b64_tr_b16 v[138:139], v8 offset:19968
    ds_read_b64_tr_b16 v[140:141], v9 offset:18496
    s_waitcnt lgkmcnt(12)
    v_mfma_f32_32x32x16_bf16 v[32:47], v[116:119], v[160:163], v[32:47]
    ds_read_b64_tr_b16 v[142:143], v9 offset:20032
    ds_read_b64_tr_b16 v[144:145], v8 offset:18560
    ds_read_b64_tr_b16 v[146:147], v8 offset:20096
    s_waitcnt lgkmcnt(13)
    v_mfma_f32_32x32x16_bf16 v[48:63], v[120:123], v[160:163], v[48:63]
    ds_read_b64_tr_b16 v[148:149], v9 offset:18624
    ds_read_b64_tr_b16 v[150:151], v9 offset:20160
    ds_read_b64_tr_b16 v[152:153], v8 offset:18688
    s_waitcnt lgkmcnt(14)
    v_mfma_f32_32x32x16_bf16 v[64:79], v[124:127], v[160:163], v[64:79]
    ds_read_b64_tr_b16 v[154:155], v8 offset:20224
    ds_read_b64_tr_b16 v[156:157], v9 offset:18752
    ds_read_b64_tr_b16 v[158:159], v9 offset:20288
    s_waitcnt lgkmcnt(15)
    v_mfma_f32_32x32x16_bf16 v[80:95], v[128:131], v[160:163], v[80:95]
    ds_read_b32 v12, v10
    s_waitcnt lgkmcnt(14)
    v_mfma_f32_32x32x16_bf16 v[96:111], v[132:135], v[160:163], v[96:111]
    s_waitcnt lgkmcnt(11)
    v_mfma_f32_32x32x16_bf16 v[16:31], v[136:139], v[164:167], v[16:31]
    s_waitcnt lgkmcnt(0)
    v_cmp_gt_u32 vcc, 31, v12
    v_add_u32 v15, 1, v15
    ds_write_b32 v1, v15
    v_mfma_f32_32x32x16_bf16 v[32:47], v[140:143], v[164:167], v[32:47]
    s_mov_b32 s61, 31
    s_getpc_b64 s[56:57]
    s_cbranch_vccnz common_slow
    ds_read_b128 v[112:115], v2 offset:32768
    ds_read_b128 v[116:119], v3 offset:32768
    v_mfma_f32_32x32x16_bf16 v[48:63], v[144:147], v[164:167], v[48:63]
    ds_read_b128 v[120:123], v4 offset:32768
    ds_read_b128 v[124:127], v5 offset:32768
    v_mfma_f32_32x32x16_bf16 v[64:79], v[148:151], v[164:167], v[64:79]
    v_mfma_f32_32x32x16_bf16 v[80:95], v[152:155], v[164:167], v[80:95]
    v_mfma_f32_32x32x16_bf16 v[96:111], v[156:159], v[164:167], v[96:111]
    s_waitcnt vmcnt(0)
    s_nop 0
    v_readfirstlane_b32 s62, v249
    s_nop 0
    s_cmp_lg_u32 s62, 0
    s_cbranch_scc0 nonce_100001
nonce_100001_ok:
    v_bfe_u32 v248, v0, 2, 2
    v_lshrrev_b32 v249, 5, v0
    v_lshl_add_u32 v248, v249, 3, v248
    v_mul_u32_u24 v248, 320, v248
    v_bfe_u32 v249, v0, 4, 1
    v_lshl_add_u32 v248, v249, 5, v248
    v_and_b32 v249, 3, v0
    v_lshl_add_u32 v248, v249, 3, v248
    v_add_u32 v6, 0x10000, v248
    v_add_u32 v8, 49152, v6
    s_lshl_b32 s51, s4, 4
    s_lshl_b32 s47, s6, 2
    s_add_u32 s51, s51, s47
    s_add_u32 s51, s51, s3
    s_lshl_b32 s51, s51, 5
    s_lshl_b32 s52, s5, 3
    s_lshl_b32 s47, s43, 2
    s_add_u32 s52, s52, s47
    s_add_u32 s52, s52, s51
    s_lshl_b32 s52, s52, 11
    s_add_u32 s52, s52, 0x0
    v_cvt_pk_bf16_f32 v168, v16, v17
    v_cvt_pk_bf16_f32 v169, v18, v19
    v_cvt_pk_bf16_f32 v170, v20, v21
    v_cvt_pk_bf16_f32 v171, v22, v23
    v_cvt_pk_bf16_f32 v172, v24, v25
    v_cvt_pk_bf16_f32 v173, v26, v27
    v_cvt_pk_bf16_f32 v174, v28, v29
    v_cvt_pk_bf16_f32 v175, v30, v31
    v_cvt_pk_bf16_f32 v176, v32, v33
    v_cvt_pk_bf16_f32 v177, v34, v35
    v_cvt_pk_bf16_f32 v178, v36, v37
    v_cvt_pk_bf16_f32 v179, v38, v39
    v_cvt_pk_bf16_f32 v180, v40, v41
    v_cvt_pk_bf16_f32 v181, v42, v43
    v_cvt_pk_bf16_f32 v182, v44, v45
    v_cvt_pk_bf16_f32 v183, v46, v47
    s_waitcnt lgkmcnt(0)
    v_add_u32 v15, 1, v15
    ds_write_b32 v1, v15
    ds_read_b32 v12, v10
    s_waitcnt lgkmcnt(0)
    v_cmp_gt_u32 vcc, 32, v12
    s_nop 4
    s_mov_b32 s61, 32
    s_getpc_b64 s[56:57]
    s_cbranch_vccnz common_slow
    ds_read_b128 v[128:131], v2 offset:49152
    ds_read_b128 v[132:135], v3 offset:49152
    ds_read_b128 v[136:139], v4 offset:49152
    ds_read_b128 v[140:143], v5 offset:49152
    v_cvt_pk_bf16_f32 v184, v48, v49
    v_cvt_pk_bf16_f32 v185, v50, v51
    v_cvt_pk_bf16_f32 v186, v52, v53
    v_cvt_pk_bf16_f32 v187, v54, v55
    v_cvt_pk_bf16_f32 v188, v56, v57
    v_cvt_pk_bf16_f32 v189, v58, v59
    v_cvt_pk_bf16_f32 v190, v60, v61
    v_cvt_pk_bf16_f32 v191, v62, v63
    v_cvt_pk_bf16_f32 v200, v64, v65
    v_cvt_pk_bf16_f32 v201, v66, v67
    v_cvt_pk_bf16_f32 v202, v68, v69
    v_cvt_pk_bf16_f32 v203, v70, v71
    v_cvt_pk_bf16_f32 v204, v72, v73
    v_cvt_pk_bf16_f32 v205, v74, v75
    v_cvt_pk_bf16_f32 v206, v76, v77
    v_cvt_pk_bf16_f32 v207, v78, v79
    s_waitcnt lgkmcnt(0)
    v_add_u32 v15, 1, v15
    ds_write_b32 v1, v15
    ds_read_b32 v12, v10
    s_waitcnt lgkmcnt(0)
    v_cmp_gt_u32 vcc, 33, v12
    s_nop 4
    s_mov_b32 s61, 33
    s_getpc_b64 s[56:57]
    s_cbranch_vccnz common_slow
    ds_read_b128 v[144:147], v2 offset:0
    ds_read_b128 v[148:151], v3 offset:0
    ds_read_b128 v[152:155], v4 offset:0
    ds_read_b128 v[156:159], v5 offset:0
    v_cvt_pk_bf16_f32 v216, v80, v81
    v_cvt_pk_bf16_f32 v217, v82, v83
    v_cvt_pk_bf16_f32 v218, v84, v85
    v_cvt_pk_bf16_f32 v219, v86, v87
    v_cvt_pk_bf16_f32 v220, v88, v89
    v_cvt_pk_bf16_f32 v221, v90, v91
    v_cvt_pk_bf16_f32 v222, v92, v93
    v_cvt_pk_bf16_f32 v223, v94, v95
    v_cvt_pk_bf16_f32 v232, v96, v97
    v_cvt_pk_bf16_f32 v233, v98, v99
    v_cvt_pk_bf16_f32 v234, v100, v101
    v_cvt_pk_bf16_f32 v235, v102, v103
    v_cvt_pk_bf16_f32 v236, v104, v105
    v_cvt_pk_bf16_f32 v237, v106, v107
    v_cvt_pk_bf16_f32 v238, v108, v109
    v_cvt_pk_bf16_f32 v239, v110, v111
    v_mfma_f32_32x32x16_bf16 v[96:111], v[112:115], v[168:171], 0
    v_mfma_f32_32x32x16_bf16 v[96:111], v[116:119], v[172:175], v[96:111]
    v_mfma_f32_32x32x16_bf16 v[96:111], v[120:123], v[176:179], v[96:111]
    v_mfma_f32_32x32x16_bf16 v[96:111], v[124:127], v[180:183], v[96:111]
    v_mfma_f32_32x32x16_bf16 v[96:111], v[128:131], v[184:187], v[96:111]
    v_mfma_f32_32x32x16_bf16 v[96:111], v[132:135], v[188:191], v[96:111]
    v_mfma_f32_32x32x16_bf16 v[96:111], v[136:139], v[200:203], v[96:111]
    v_mfma_f32_32x32x16_bf16 v[96:111], v[140:143], v[204:207], v[96:111]
    s_waitcnt lgkmcnt(0)
    v_add_u32 v15, 1, v15
    ds_write_b32 v1, v15
    ds_read_b32 v12, v10
    v_mfma_f32_32x32x16_bf16 v[96:111], v[144:147], v[216:219], v[96:111]
    v_mfma_f32_32x32x16_bf16 v[96:111], v[148:151], v[220:223], v[96:111]
    s_waitcnt lgkmcnt(0)
    v_cmp_gt_u32 vcc, 36, v12
    v_mfma_f32_32x32x16_bf16 v[96:111], v[152:155], v[232:235], v[96:111]
    s_mov_b32 s61, 36
    s_getpc_b64 s[56:57]
    s_cbranch_vccnz common_slow
    ds_read_b128 v[160:163], v2 offset:16384
    ds_read_b64_tr_b16 v[112:113], v8 offset:24576
    ds_read_b64_tr_b16 v[114:115], v8 offset:25856
    ds_read_b64_tr_b16 v[116:117], v8 offset:24640
    ds_read_b64_tr_b16 v[118:119], v8 offset:25920
    ds_read_b64_tr_b16 v[120:121], v8 offset:24704
    ds_read_b64_tr_b16 v[122:123], v8 offset:25984
    ds_read_b64_tr_b16 v[124:125], v8 offset:24768
    ds_read_b64_tr_b16 v[126:127], v8 offset:26048
    ds_read_b64_tr_b16 v[128:129], v8 offset:24832
    ds_read_b64_tr_b16 v[130:131], v8 offset:26112
    v_mfma_f32_32x32x16_bf16 v[96:111], v[156:159], v[236:239], v[96:111]
    s_mov_b32 s50, 0x3dd53b95
    s_add_u32 s53, s51, s46
    s_lshl_b32 s53, s53, 11
    s_add_u32 s53, s53, 0x0
    s_waitcnt lgkmcnt(8)
    v_mfma_f32_32x32x16_bf16 v[16:31], v[160:163], v[112:115], 0
    ds_read_b128 v[164:167], v3 offset:16384
    ds_read_b64_tr_b16 v[136:137], v8 offset:29696
    ds_read_b64_tr_b16 v[138:139], v8 offset:30976
    ds_read_b64_tr_b16 v[140:141], v8 offset:29760
    s_nop 7
    s_waitcnt lgkmcnt(10)
    v_mfma_f32_32x32x16_bf16 v[32:47], v[160:163], v[116:119], 0
    ds_read_b64_tr_b16 v[142:143], v8 offset:31040
    ds_read_b64_tr_b16 v[144:145], v8 offset:29824
    ds_read_b64_tr_b16 v[146:147], v8 offset:31104
    ds_read_b64_tr_b16 v[148:149], v8 offset:29888
    v_max3_f32 v248, v96, v97, v98
    s_waitcnt lgkmcnt(12)
    v_mfma_f32_32x32x16_bf16 v[48:63], v[160:163], v[120:123], 0
    ds_read_b64_tr_b16 v[150:151], v8 offset:31168
    ds_read_b64_tr_b16 v[152:153], v8 offset:29952
    ds_read_b64_tr_b16 v[154:155], v8 offset:31232
    v_max3_f32 v248, v248, v99, v100
    v_max3_f32 v248, v248, v101, v102
    s_waitcnt lgkmcnt(13)
    v_mfma_f32_32x32x16_bf16 v[64:79], v[160:163], v[124:127], 0
    v_max3_f32 v248, v248, v103, v104
    v_max3_f32 v248, v248, v105, v106
    v_max3_f32 v248, v248, v107, v108
    v_max3_f32 v248, v248, v109, v110
    v_max_f32 v248, v248, v111
    s_waitcnt lgkmcnt(11)
    v_mfma_f32_32x32x16_bf16 v[80:95], v[160:163], v[128:131], 0
    v_mov_b32 v249, v248
    s_nop 1
    v_permlane32_swap_b32 v248, v249
    v_max_f32 v248, v248, v249
    v_mul_f32 v250, s50, v248
    s_waitcnt lgkmcnt(8)
    v_mfma_f32_32x32x16_bf16 v[16:31], v[164:167], v[136:139], v[16:31]
    s_waitcnt lgkmcnt(0)
    v_add_u32 v15, 1, v15
    v_fma_f32 v96, v96, s50, -v250
    v_fma_f32 v97, v97, s50, -v250
    v_fma_f32 v98, v98, s50, -v250
    v_fma_f32 v99, v99, s50, -v250
    v_fma_f32 v100, v100, s50, -v250
    v_mfma_f32_32x32x16_bf16 v[32:47], v[164:167], v[140:143], v[32:47]
    ds_read_b128 v[160:163], v4 offset:16384
    ds_read_b64_tr_b16 v[112:113], v6 offset:0
    ds_read_b64_tr_b16 v[114:115], v6 offset:1280
    ds_read_b64_tr_b16 v[116:117], v6 offset:64
    v_fma_f32 v101, v101, s50, -v250
    v_mfma_f32_32x32x16_bf16 v[48:63], v[164:167], v[144:147], v[48:63]
    ds_read_b64_tr_b16 v[118:119], v6 offset:1344
    ds_read_b64_tr_b16 v[120:121], v6 offset:128
    ds_read_b64_tr_b16 v[122:123], v6 offset:1408
    ds_read_b64_tr_b16 v[124:125], v6 offset:192
    v_fma_f32 v102, v102, s50, -v250
    v_mfma_f32_32x32x16_bf16 v[64:79], v[164:167], v[148:151], v[64:79]
    ds_read_b64_tr_b16 v[126:127], v6 offset:1472
    ds_read_b64_tr_b16 v[128:129], v6 offset:256
    ds_read_b64_tr_b16 v[130:131], v6 offset:1536
    v_fma_f32 v103, v103, s50, -v250
    v_fma_f32 v104, v104, s50, -v250
    v_mfma_f32_32x32x16_bf16 v[80:95], v[164:167], v[152:155], v[80:95]
    v_fma_f32 v105, v105, s50, -v250
    v_fma_f32 v106, v106, s50, -v250
    v_fma_f32 v107, v107, s50, -v250
    v_fma_f32 v108, v108, s50, -v250
    v_fma_f32 v109, v109, s50, -v250
    s_waitcnt lgkmcnt(8)
    v_mfma_f32_32x32x16_bf16 v[16:31], v[160:163], v[112:115], v[16:31]
    ds_read_b128 v[164:167], v5 offset:16384
    ds_read_b64_tr_b16 v[136:137], v6 offset:5120
    ds_read_b64_tr_b16 v[138:139], v6 offset:6400
    ds_read_b64_tr_b16 v[140:141], v6 offset:5184
    v_fma_f32 v110, v110, s50, -v250
    s_waitcnt lgkmcnt(10)
    v_mfma_f32_32x32x16_bf16 v[32:47], v[160:163], v[116:119], v[32:47]
    ds_read_b64_tr_b16 v[142:143], v6 offset:6464
    ds_read_b64_tr_b16 v[144:145], v6 offset:5248
    ds_read_b64_tr_b16 v[146:147], v6 offset:6528
    ds_read_b64_tr_b16 v[148:149], v6 offset:5312
    v_fma_f32 v111, v111, s50, -v250
    s_waitcnt lgkmcnt(12)
    v_mfma_f32_32x32x16_bf16 v[48:63], v[160:163], v[120:123], v[48:63]
    ds_read_b64_tr_b16 v[150:151], v6 offset:6592
    ds_read_b64_tr_b16 v[152:153], v6 offset:5376
    ds_read_b64_tr_b16 v[154:155], v6 offset:6656
    v_exp_f32 v96, v96
    v_exp_f32 v97, v97
    s_waitcnt lgkmcnt(13)
    v_mfma_f32_32x32x16_bf16 v[64:79], v[160:163], v[124:127], v[64:79]
    ds_read_b32 v12, v10
    v_exp_f32 v98, v98
    v_exp_f32 v99, v99
    v_exp_f32 v100, v100
    v_exp_f32 v101, v101
    v_exp_f32 v102, v102
    s_waitcnt lgkmcnt(12)
    v_mfma_f32_32x32x16_bf16 v[80:95], v[160:163], v[128:131], v[80:95]
    v_exp_f32 v103, v103
    v_exp_f32 v104, v104
    v_exp_f32 v105, v105
    v_exp_f32 v106, v106
    v_exp_f32 v107, v107
    s_waitcnt lgkmcnt(9)
    v_mfma_f32_32x32x16_bf16 v[16:31], v[164:167], v[136:139], v[16:31]
    s_waitcnt lgkmcnt(0)
    v_cmp_gt_u32 vcc, 39, v12
    v_add_u32 v15, 1, v15
    ds_write_b32 v1, v15
    v_exp_f32 v108, v108
    v_exp_f32 v109, v109
    v_exp_f32 v110, v110
    v_exp_f32 v111, v111
    s_nop 0
    v_mfma_f32_32x32x16_bf16 v[32:47], v[164:167], v[140:143], v[32:47]
    s_mov_b32 s61, 39
    s_getpc_b64 s[56:57]
    s_cbranch_vccnz common_slow
    ds_read_b128 v[160:163], v2 offset:32768
    ds_read_b64_tr_b16 v[112:113], v6 offset:12288
    ds_read_b64_tr_b16 v[114:115], v6 offset:13568
    ds_read_b64_tr_b16 v[116:117], v6 offset:12352
    v_add_f32 v248, v96, v97
    v_mfma_f32_32x32x16_bf16 v[48:63], v[164:167], v[144:147], v[48:63]
    ds_read_b64_tr_b16 v[118:119], v6 offset:13632
    ds_read_b64_tr_b16 v[120:121], v6 offset:12416
    ds_read_b64_tr_b16 v[122:123], v6 offset:13696
    ds_read_b64_tr_b16 v[124:125], v6 offset:12480
    v_add_f32 v249, v98, v99
    v_mfma_f32_32x32x16_bf16 v[64:79], v[164:167], v[148:151], v[64:79]
    ds_read_b64_tr_b16 v[126:127], v6 offset:13760
    ds_read_b64_tr_b16 v[128:129], v6 offset:12544
    ds_read_b64_tr_b16 v[130:131], v6 offset:13824
    v_add_f32 v248, v248, v100
    v_add_f32 v249, v249, v101
    v_mfma_f32_32x32x16_bf16 v[80:95], v[164:167], v[152:155], v[80:95]
    v_add_f32 v248, v248, v102
    v_add_f32 v249, v249, v103
    v_add_f32 v248, v248, v104
    v_add_f32 v249, v249, v105
    v_add_f32 v248, v248, v106
    s_waitcnt lgkmcnt(8)
    v_mfma_f32_32x32x16_bf16 v[16:31], v[160:163], v[112:115], v[16:31]
    ds_read_b128 v[164:167], v3 offset:32768
    ds_read_b64_tr_b16 v[136:137], v6 offset:17408
    ds_read_b64_tr_b16 v[138:139], v6 offset:18688
    ds_read_b64_tr_b16 v[140:141], v6 offset:17472
    v_add_f32 v249, v249, v107
    s_waitcnt lgkmcnt(10)
    v_mfma_f32_32x32x16_bf16 v[32:47], v[160:163], v[116:119], v[32:47]
    ds_read_b64_tr_b16 v[142:143], v6 offset:18752
    ds_read_b64_tr_b16 v[144:145], v6 offset:17536
    ds_read_b64_tr_b16 v[146:147], v6 offset:18816
    ds_read_b64_tr_b16 v[148:149], v6 offset:17600
    v_add_f32 v248, v248, v108
    s_waitcnt lgkmcnt(12)
    v_mfma_f32_32x32x16_bf16 v[48:63], v[160:163], v[120:123], v[48:63]
    ds_read_b64_tr_b16 v[150:151], v6 offset:18880
    ds_read_b64_tr_b16 v[152:153], v6 offset:17664
    ds_read_b64_tr_b16 v[154:155], v6 offset:18944
    v_add_f32 v249, v249, v109
    v_add_f32 v248, v248, v110
    s_waitcnt lgkmcnt(13)
    v_mfma_f32_32x32x16_bf16 v[64:79], v[160:163], v[124:127], v[64:79]
    v_add_f32 v249, v249, v111
    v_add_f32 v248, v248, v249
    v_mov_b32 v249, v248
    s_nop 1
    v_permlane32_swap_b32 v248, v249
    s_waitcnt lgkmcnt(11)
    v_mfma_f32_32x32x16_bf16 v[80:95], v[160:163], v[128:131], v[80:95]
    v_add_f32 v248, v248, v249
    v_rcp_f32 v248, v248
    s_nop 0
    v_mul_f32 v96, v96, v248
    v_mul_f32 v97, v97, v248
    s_waitcnt lgkmcnt(8)
    v_mfma_f32_32x32x16_bf16 v[16:31], v[164:167], v[136:139], v[16:31]
    s_waitcnt lgkmcnt(0)
    v_add_u32 v15, 1, v15
    v_mul_f32 v98, v98, v248
    v_mul_f32 v99, v99, v248
    v_mul_f32 v100, v100, v248
    v_mul_f32 v101, v101, v248
    v_mul_f32 v102, v102, v248
    v_mfma_f32_32x32x16_bf16 v[32:47], v[164:167], v[140:143], v[32:47]
    ds_read_b128 v[160:163], v4 offset:32768
    ds_read_b64_tr_b16 v[112:113], v6 offset:24576
    ds_read_b64_tr_b16 v[114:115], v6 offset:25856
    ds_read_b64_tr_b16 v[116:117], v6 offset:24640
    v_mul_f32 v103, v103, v248
    v_mfma_f32_32x32x16_bf16 v[48:63], v[164:167], v[144:147], v[48:63]
    ds_read_b64_tr_b16 v[118:119], v6 offset:25920
    ds_read_b64_tr_b16 v[120:121], v6 offset:24704
    ds_read_b64_tr_b16 v[122:123], v6 offset:25984
    ds_read_b64_tr_b16 v[124:125], v6 offset:24768
    v_mul_f32 v104, v104, v248
    v_mfma_f32_32x32x16_bf16 v[64:79], v[164:167], v[148:151], v[64:79]
    ds_read_b64_tr_b16 v[126:127], v6 offset:26048
    ds_read_b64_tr_b16 v[128:129], v6 offset:24832
    ds_read_b64_tr_b16 v[130:131], v6 offset:26112
    v_mul_f32 v105, v105, v248
    v_mul_f32 v106, v106, v248
    v_mfma_f32_32x32x16_bf16 v[80:95], v[164:167], v[152:155], v[80:95]
    v_mul_f32 v107, v107, v248
    v_mul_f32 v108, v108, v248
    v_mul_f32 v109, v109, v248
    v_mul_f32 v110, v110, v248
    v_mul_f32 v111, v111, v248
    s_waitcnt lgkmcnt(8)
    v_mfma_f32_32x32x16_bf16 v[16:31], v[160:163], v[112:115], v[16:31]
    ds_read_b128 v[164:167], v5 offset:32768
    ds_read_b64_tr_b16 v[136:137], v6 offset:29696
    ds_read_b64_tr_b16 v[138:139], v6 offset:30976
    ds_read_b64_tr_b16 v[140:141], v6 offset:29760
    v_cvt_pk_bf16_f32 v168, v96, v97
    s_waitcnt lgkmcnt(10)
    v_mfma_f32_32x32x16_bf16 v[32:47], v[160:163], v[116:119], v[32:47]
    ds_read_b64_tr_b16 v[142:143], v6 offset:31040
    ds_read_b64_tr_b16 v[144:145], v6 offset:29824
    ds_read_b64_tr_b16 v[146:147], v6 offset:31104
    ds_read_b64_tr_b16 v[148:149], v6 offset:29888
    v_cvt_pk_bf16_f32 v169, v98, v99
    s_waitcnt lgkmcnt(12)
    v_mfma_f32_32x32x16_bf16 v[48:63], v[160:163], v[120:123], v[48:63]
    ds_read_b64_tr_b16 v[150:151], v6 offset:31168
    ds_read_b64_tr_b16 v[152:153], v6 offset:29952
    ds_read_b64_tr_b16 v[154:155], v6 offset:31232
    v_cvt_pk_bf16_f32 v170, v100, v101
    v_cvt_pk_bf16_f32 v171, v102, v103
    s_waitcnt lgkmcnt(13)
    v_mfma_f32_32x32x16_bf16 v[64:79], v[160:163], v[124:127], v[64:79]
    ds_read_b32 v12, v10
    v_cvt_pk_bf16_f32 v172, v104, v105
    v_cvt_pk_bf16_f32 v173, v106, v107
    v_cvt_pk_bf16_f32 v174, v108, v109
    v_cvt_pk_bf16_f32 v175, v110, v111
    buffer_store_dwordx4 v[168:171], v11, s[28:31], s53 offen sc1
    s_waitcnt lgkmcnt(12)
    v_mfma_f32_32x32x16_bf16 v[80:95], v[160:163], v[128:131], v[80:95]
    buffer_store_dwordx4 v[172:175], v11, s[28:31], s53 offen offset:1024 sc1
    s_waitcnt lgkmcnt(9)
    v_mfma_f32_32x32x16_bf16 v[16:31], v[164:167], v[136:139], v[16:31]
    s_waitcnt lgkmcnt(0)
    v_cmp_gt_u32 vcc, 42, v12
    v_add_u32 v15, 1, v15
    ds_write_b32 v1, v15
    v_mfma_f32_32x32x16_bf16 v[32:47], v[164:167], v[140:143], v[32:47]
    s_mov_b32 s61, 42
    s_getpc_b64 s[56:57]
    s_cbranch_vccnz common_slow
    ds_read_b128 v[160:163], v2 offset:49152
    ds_read_b64_tr_b16 v[112:113], v6 offset:36864
    ds_read_b64_tr_b16 v[114:115], v6 offset:38144
    ds_read_b64_tr_b16 v[116:117], v6 offset:36928
    v_mfma_f32_32x32x16_bf16 v[48:63], v[164:167], v[144:147], v[48:63]
    ds_read_b64_tr_b16 v[118:119], v6 offset:38208
    ds_read_b64_tr_b16 v[120:121], v6 offset:36992
    ds_read_b64_tr_b16 v[122:123], v6 offset:38272
    ds_read_b64_tr_b16 v[124:125], v6 offset:37056
    v_mfma_f32_32x32x16_bf16 v[64:79], v[164:167], v[148:151], v[64:79]
    ds_read_b64_tr_b16 v[126:127], v6 offset:38336
    ds_read_b64_tr_b16 v[128:129], v6 offset:37120
    ds_read_b64_tr_b16 v[130:131], v6 offset:38400
    v_mfma_f32_32x32x16_bf16 v[80:95], v[164:167], v[152:155], v[80:95]
    s_waitcnt lgkmcnt(8)
    v_mfma_f32_32x32x16_bf16 v[16:31], v[160:163], v[112:115], v[16:31]
    s_waitcnt vmcnt(0)
    s_lshl_b32 s47, s2, 2
    s_add_u32 s47, s47, s3
    s_lshl_b32 s47, s47, 6
    s_add_u32 s47, s47, 0x300000
    v_mov_b32 v248, 0
    v_mov_b32 v249, s62
    s_mov_b64 exec, 1
    buffer_store_dword v249, v248, s[28:31], s47 offen sc1
    s_mov_b64 exec, -1
    ds_read_b128 v[164:167], v3 offset:49152
    ds_read_b64_tr_b16 v[136:137], v6 offset:41984
    ds_read_b64_tr_b16 v[138:139], v6 offset:43264
    ds_read_b64_tr_b16 v[140:141], v6 offset:42048
    s_waitcnt lgkmcnt(10)
    v_mfma_f32_32x32x16_bf16 v[32:47], v[160:163], v[116:119], v[32:47]
    ds_read_b64_tr_b16 v[142:143], v6 offset:43328
    ds_read_b64_tr_b16 v[144:145], v6 offset:42112
    ds_read_b64_tr_b16 v[146:147], v6 offset:43392
    ds_read_b64_tr_b16 v[148:149], v6 offset:42176
    s_waitcnt lgkmcnt(12)
    v_mfma_f32_32x32x16_bf16 v[48:63], v[160:163], v[120:123], v[48:63]
    ds_read_b64_tr_b16 v[150:151], v6 offset:43456
    ds_read_b64_tr_b16 v[152:153], v6 offset:42240
    ds_read_b64_tr_b16 v[154:155], v6 offset:43520
    s_waitcnt lgkmcnt(13)
    v_mfma_f32_32x32x16_bf16 v[64:79], v[160:163], v[124:127], v[64:79]
    s_waitcnt lgkmcnt(11)
    v_mfma_f32_32x32x16_bf16 v[80:95], v[160:163], v[128:131], v[80:95]
    s_waitcnt lgkmcnt(8)
    v_mfma_f32_32x32x16_bf16 v[16:31], v[164:167], v[136:139], v[16:31]
    s_waitcnt lgkmcnt(0)
    v_add_u32 v15, 1, v15
    v_mfma_f32_32x32x16_bf16 v[32:47], v[164:167], v[140:143], v[32:47]
    ds_read_b128 v[160:163], v4 offset:49152
    ds_read_b64_tr_b16 v[112:113], v8 offset:0
    ds_read_b64_tr_b16 v[114:115], v8 offset:1280
    ds_read_b64_tr_b16 v[116:117], v8 offset:64
    v_mfma_f32_32x32x16_bf16 v[48:63], v[164:167], v[144:147], v[48:63]
    ds_read_b64_tr_b16 v[118:119], v8 offset:1344
    ds_read_b64_tr_b16 v[120:121], v8 offset:128
    ds_read_b64_tr_b16 v[122:123], v8 offset:1408
    ds_read_b64_tr_b16 v[124:125], v8 offset:192
    v_mfma_f32_32x32x16_bf16 v[64:79], v[164:167], v[148:151], v[64:79]
    ds_read_b64_tr_b16 v[126:127], v8 offset:1472
    ds_read_b64_tr_b16 v[128:129], v8 offset:256
    ds_read_b64_tr_b16 v[130:131], v8 offset:1536
    v_mfma_f32_32x32x16_bf16 v[80:95], v[164:167], v[152:155], v[80:95]
    s_waitcnt lgkmcnt(8)
    v_mfma_f32_32x32x16_bf16 v[16:31], v[160:163], v[112:115], v[16:31]
    ds_read_b128 v[164:167], v5 offset:49152
    ds_read_b64_tr_b16 v[136:137], v8 offset:5120
    ds_read_b64_tr_b16 v[138:139], v8 offset:6400
    ds_read_b64_tr_b16 v[140:141], v8 offset:5184
    s_waitcnt lgkmcnt(10)
    v_mfma_f32_32x32x16_bf16 v[32:47], v[160:163], v[116:119], v[32:47]
    ds_read_b64_tr_b16 v[142:143], v8 offset:6464
    ds_read_b64_tr_b16 v[144:145], v8 offset:5248
    ds_read_b64_tr_b16 v[146:147], v8 offset:6528
    ds_read_b64_tr_b16 v[148:149], v8 offset:5312
    s_waitcnt lgkmcnt(12)
    v_mfma_f32_32x32x16_bf16 v[48:63], v[160:163], v[120:123], v[48:63]
    ds_read_b64_tr_b16 v[150:151], v8 offset:6592
    ds_read_b64_tr_b16 v[152:153], v8 offset:5376
    ds_read_b64_tr_b16 v[154:155], v8 offset:6656
    s_waitcnt lgkmcnt(13)
    v_mfma_f32_32x32x16_bf16 v[64:79], v[160:163], v[124:127], v[64:79]
    ds_read_b32 v12, v10
    s_waitcnt lgkmcnt(12)
    v_mfma_f32_32x32x16_bf16 v[80:95], v[160:163], v[128:131], v[80:95]
    s_waitcnt lgkmcnt(9)
    v_mfma_f32_32x32x16_bf16 v[16:31], v[164:167], v[136:139], v[16:31]
    s_waitcnt lgkmcnt(0)
    v_cmp_gt_u32 vcc, 45, v12
    v_add_u32 v15, 1, v15
    ds_write_b32 v1, v15
    v_mfma_f32_32x32x16_bf16 v[32:47], v[164:167], v[140:143], v[32:47]
    s_mov_b32 s61, 45
    s_getpc_b64 s[56:57]
    s_cbranch_vccnz common_slow
    ds_read_b128 v[160:163], v2 offset:0
    ds_read_b64_tr_b16 v[112:113], v8 offset:12288
    ds_read_b64_tr_b16 v[114:115], v8 offset:13568
    ds_read_b64_tr_b16 v[116:117], v8 offset:12352
    v_mfma_f32_32x32x16_bf16 v[48:63], v[164:167], v[144:147], v[48:63]
    ds_read_b64_tr_b16 v[118:119], v8 offset:13632
    ds_read_b64_tr_b16 v[120:121], v8 offset:12416
    ds_read_b64_tr_b16 v[122:123], v8 offset:13696
    ds_read_b64_tr_b16 v[124:125], v8 offset:12480
    v_mfma_f32_32x32x16_bf16 v[64:79], v[164:167], v[148:151], v[64:79]
    ds_read_b64_tr_b16 v[126:127], v8 offset:13760
    ds_read_b64_tr_b16 v[128:129], v8 offset:12544
    ds_read_b64_tr_b16 v[130:131], v8 offset:13824
    v_mfma_f32_32x32x16_bf16 v[80:95], v[164:167], v[152:155], v[80:95]
    s_nop 7
    s_nop 3
    v_cvt_pk_bf16_f32 v192, v16, v17
    v_cvt_pk_bf16_f32 v193, v18, v19
    v_cvt_pk_bf16_f32 v194, v20, v21
    v_cvt_pk_bf16_f32 v195, v22, v23
    v_cvt_pk_bf16_f32 v196, v24, v25
    v_cvt_pk_bf16_f32 v197, v26, v27
    v_cvt_pk_bf16_f32 v198, v28, v29
    v_cvt_pk_bf16_f32 v199, v30, v31
    v_cvt_pk_bf16_f32 v208, v32, v33
    v_cvt_pk_bf16_f32 v209, v34, v35
    v_cvt_pk_bf16_f32 v210, v36, v37
    v_cvt_pk_bf16_f32 v211, v38, v39
    v_cvt_pk_bf16_f32 v212, v40, v41
    v_cvt_pk_bf16_f32 v213, v42, v43
    v_cvt_pk_bf16_f32 v214, v44, v45
    v_cvt_pk_bf16_f32 v215, v46, v47
    v_cvt_pk_bf16_f32 v224, v48, v49
    v_cvt_pk_bf16_f32 v225, v50, v51
    v_cvt_pk_bf16_f32 v226, v52, v53
    v_cvt_pk_bf16_f32 v227, v54, v55
    v_cvt_pk_bf16_f32 v228, v56, v57
    v_cvt_pk_bf16_f32 v229, v58, v59
    v_cvt_pk_bf16_f32 v230, v60, v61
    v_cvt_pk_bf16_f32 v231, v62, v63
    v_cvt_pk_bf16_f32 v240, v64, v65
    v_cvt_pk_bf16_f32 v241, v66, v67
    v_cvt_pk_bf16_f32 v242, v68, v69
    v_cvt_pk_bf16_f32 v243, v70, v71
    v_cvt_pk_bf16_f32 v244, v72, v73
    v_cvt_pk_bf16_f32 v245, v74, v75
    v_cvt_pk_bf16_f32 v246, v76, v77
    v_cvt_pk_bf16_f32 v247, v78, v79
    v_cvt_pk_bf16_f32 v104, v80, v81
    v_cvt_pk_bf16_f32 v105, v82, v83
    v_cvt_pk_bf16_f32 v106, v84, v85
    v_cvt_pk_bf16_f32 v107, v86, v87
    v_cvt_pk_bf16_f32 v108, v88, v89
    v_cvt_pk_bf16_f32 v109, v90, v91
    v_cvt_pk_bf16_f32 v110, v92, v93
    v_cvt_pk_bf16_f32 v111, v94, v95
    s_waitcnt lgkmcnt(8)
    v_mfma_f32_32x32x16_bf16 v[16:31], v[160:163], v[112:115], 0
    ds_read_b128 v[164:167], v3 offset:0
    ds_read_b64_tr_b16 v[136:137], v8 offset:17408
    ds_read_b64_tr_b16 v[138:139], v8 offset:18688
    ds_read_b64_tr_b16 v[140:141], v8 offset:17472
    s_waitcnt lgkmcnt(10)
    v_mfma_f32_32x32x16_bf16 v[32:47], v[160:163], v[116:119], 0
    ds_read_b64_tr_b16 v[142:143], v8 offset:18752
    ds_read_b64_tr_b16 v[144:145], v8 offset:17536
    ds_read_b64_tr_b16 v[146:147], v8 offset:18816
    ds_read_b64_tr_b16 v[148:149], v8 offset:17600
    s_waitcnt lgkmcnt(12)
    v_mfma_f32_32x32x16_bf16 v[48:63], v[160:163], v[120:123], 0
    ds_read_b64_tr_b16 v[150:151], v8 offset:18880
    ds_read_b64_tr_b16 v[152:153], v8 offset:17664
    ds_read_b64_tr_b16 v[154:155], v8 offset:18944
    s_waitcnt lgkmcnt(13)
    v_mfma_f32_32x32x16_bf16 v[64:79], v[160:163], v[124:127], 0
    s_waitcnt lgkmcnt(11)
    v_mfma_f32_32x32x16_bf16 v[80:95], v[160:163], v[128:131], 0
    s_waitcnt lgkmcnt(8)
    v_mfma_f32_32x32x16_bf16 v[16:31], v[164:167], v[136:139], v[16:31]
    s_waitcnt lgkmcnt(0)
    v_add_u32 v15, 1, v15
    v_mfma_f32_32x32x16_bf16 v[32:47], v[164:167], v[140:143], v[32:47]
    ds_read_b128 v[160:163], v4 offset:0
    ds_read_b64_tr_b16 v[112:113], v8 offset:24576
    ds_read_b64_tr_b16 v[114:115], v8 offset:25856
    ds_read_b64_tr_b16 v[116:117], v8 offset:24640
    v_mfma_f32_32x32x16_bf16 v[48:63], v[164:167], v[144:147], v[48:63]
    ds_read_b64_tr_b16 v[118:119], v8 offset:25920
    ds_read_b64_tr_b16 v[120:121], v8 offset:24704
    ds_read_b64_tr_b16 v[122:123], v8 offset:25984
    ds_read_b64_tr_b16 v[124:125], v8 offset:24768
    v_mfma_f32_32x32x16_bf16 v[64:79], v[164:167], v[148:151], v[64:79]
    ds_read_b64_tr_b16 v[126:127], v8 offset:26048
    ds_read_b64_tr_b16 v[128:129], v8 offset:24832
    ds_read_b64_tr_b16 v[130:131], v8 offset:26112
    v_mfma_f32_32x32x16_bf16 v[80:95], v[164:167], v[152:155], v[80:95]
    s_waitcnt lgkmcnt(8)
    v_mfma_f32_32x32x16_bf16 v[16:31], v[160:163], v[112:115], v[16:31]
    ds_read_b128 v[164:167], v5 offset:0
    ds_read_b64_tr_b16 v[136:137], v8 offset:29696
    ds_read_b64_tr_b16 v[138:139], v8 offset:30976
    ds_read_b64_tr_b16 v[140:141], v8 offset:29760
    s_waitcnt lgkmcnt(10)
    v_mfma_f32_32x32x16_bf16 v[32:47], v[160:163], v[116:119], v[32:47]
    ds_read_b64_tr_b16 v[142:143], v8 offset:31040
    ds_read_b64_tr_b16 v[144:145], v8 offset:29824
    ds_read_b64_tr_b16 v[146:147], v8 offset:31104
    ds_read_b64_tr_b16 v[148:149], v8 offset:29888
    s_waitcnt lgkmcnt(12)
    v_mfma_f32_32x32x16_bf16 v[48:63], v[160:163], v[120:123], v[48:63]
    ds_read_b64_tr_b16 v[150:151], v8 offset:31168
    ds_read_b64_tr_b16 v[152:153], v8 offset:29952
    ds_read_b64_tr_b16 v[154:155], v8 offset:31232
    s_waitcnt lgkmcnt(13)
    v_mfma_f32_32x32x16_bf16 v[64:79], v[160:163], v[124:127], v[64:79]
    ds_read_b32 v12, v10
    s_waitcnt lgkmcnt(12)
    v_mfma_f32_32x32x16_bf16 v[80:95], v[160:163], v[128:131], v[80:95]
    s_waitcnt lgkmcnt(9)
    v_mfma_f32_32x32x16_bf16 v[16:31], v[164:167], v[136:139], v[16:31]
    s_waitcnt lgkmcnt(0)
    v_cmp_gt_u32 vcc, 48, v12
    v_add_u32 v15, 1, v15
    ds_write_b32 v1, v15
    v_mfma_f32_32x32x16_bf16 v[32:47], v[164:167], v[140:143], v[32:47]
    s_mov_b32 s61, 48
    s_getpc_b64 s[56:57]
    s_cbranch_vccnz common_slow
    ds_read_b128 v[160:163], v2 offset:16384
    ds_read_b64_tr_b16 v[112:113], v6 offset:0
    ds_read_b64_tr_b16 v[114:115], v6 offset:1280
    ds_read_b64_tr_b16 v[116:117], v6 offset:64
    v_mfma_f32_32x32x16_bf16 v[48:63], v[164:167], v[144:147], v[48:63]
    ds_read_b64_tr_b16 v[118:119], v6 offset:1344
    ds_read_b64_tr_b16 v[120:121], v6 offset:128
    ds_read_b64_tr_b16 v[122:123], v6 offset:1408
    ds_read_b64_tr_b16 v[124:125], v6 offset:192
    v_mfma_f32_32x32x16_bf16 v[64:79], v[164:167], v[148:151], v[64:79]
    ds_read_b64_tr_b16 v[126:127], v6 offset:1472
    ds_read_b64_tr_b16 v[128:129], v6 offset:256
    ds_read_b64_tr_b16 v[130:131], v6 offset:1536
    v_mfma_f32_32x32x16_bf16 v[80:95], v[164:167], v[152:155], v[80:95]
    s_waitcnt lgkmcnt(8)
    v_mfma_f32_32x32x16_bf16 v[16:31], v[160:163], v[112:115], v[16:31]
    ds_read_b128 v[164:167], v3 offset:16384
    ds_read_b64_tr_b16 v[136:137], v6 offset:5120
    ds_read_b64_tr_b16 v[138:139], v6 offset:6400
    ds_read_b64_tr_b16 v[140:141], v6 offset:5184
    s_waitcnt lgkmcnt(10)
    v_mfma_f32_32x32x16_bf16 v[32:47], v[160:163], v[116:119], v[32:47]
    ds_read_b64_tr_b16 v[142:143], v6 offset:6464
    ds_read_b64_tr_b16 v[144:145], v6 offset:5248
    ds_read_b64_tr_b16 v[146:147], v6 offset:6528
    ds_read_b64_tr_b16 v[148:149], v6 offset:5312
    s_waitcnt lgkmcnt(12)
    v_mfma_f32_32x32x16_bf16 v[48:63], v[160:163], v[120:123], v[48:63]
    ds_read_b64_tr_b16 v[150:151], v6 offset:6592
    ds_read_b64_tr_b16 v[152:153], v6 offset:5376
    ds_read_b64_tr_b16 v[154:155], v6 offset:6656
    s_waitcnt lgkmcnt(13)
    v_mfma_f32_32x32x16_bf16 v[64:79], v[160:163], v[124:127], v[64:79]
    s_waitcnt lgkmcnt(11)
    v_mfma_f32_32x32x16_bf16 v[80:95], v[160:163], v[128:131], v[80:95]
    s_waitcnt lgkmcnt(8)
    v_mfma_f32_32x32x16_bf16 v[16:31], v[164:167], v[136:139], v[16:31]
    s_waitcnt lgkmcnt(0)
    v_add_u32 v15, 1, v15
    v_mfma_f32_32x32x16_bf16 v[32:47], v[164:167], v[140:143], v[32:47]
    ds_read_b128 v[160:163], v4 offset:16384
    ds_read_b64_tr_b16 v[112:113], v6 offset:12288
    ds_read_b64_tr_b16 v[114:115], v6 offset:13568
    ds_read_b64_tr_b16 v[116:117], v6 offset:12352
    v_mfma_f32_32x32x16_bf16 v[48:63], v[164:167], v[144:147], v[48:63]
    ds_read_b64_tr_b16 v[118:119], v6 offset:13632
    ds_read_b64_tr_b16 v[120:121], v6 offset:12416
    ds_read_b64_tr_b16 v[122:123], v6 offset:13696
    ds_read_b64_tr_b16 v[124:125], v6 offset:12480
    v_mfma_f32_32x32x16_bf16 v[64:79], v[164:167], v[148:151], v[64:79]
    ds_read_b64_tr_b16 v[126:127], v6 offset:13760
    ds_read_b64_tr_b16 v[128:129], v6 offset:12544
    ds_read_b64_tr_b16 v[130:131], v6 offset:13824
    v_mfma_f32_32x32x16_bf16 v[80:95], v[164:167], v[152:155], v[80:95]
    s_waitcnt lgkmcnt(8)
    v_mfma_f32_32x32x16_bf16 v[16:31], v[160:163], v[112:115], v[16:31]
    ds_read_b128 v[164:167], v5 offset:16384
    ds_read_b64_tr_b16 v[136:137], v6 offset:17408
    ds_read_b64_tr_b16 v[138:139], v6 offset:18688
    ds_read_b64_tr_b16 v[140:141], v6 offset:17472
    s_waitcnt lgkmcnt(10)
    v_mfma_f32_32x32x16_bf16 v[32:47], v[160:163], v[116:119], v[32:47]
    ds_read_b64_tr_b16 v[142:143], v6 offset:18752
    ds_read_b64_tr_b16 v[144:145], v6 offset:17536
    ds_read_b64_tr_b16 v[146:147], v6 offset:18816
    ds_read_b64_tr_b16 v[148:149], v6 offset:17600
    s_waitcnt lgkmcnt(12)
    v_mfma_f32_32x32x16_bf16 v[48:63], v[160:163], v[120:123], v[48:63]
    ds_read_b64_tr_b16 v[150:151], v6 offset:18880
    ds_read_b64_tr_b16 v[152:153], v6 offset:17664
    ds_read_b64_tr_b16 v[154:155], v6 offset:18944
    s_waitcnt lgkmcnt(13)
    v_mfma_f32_32x32x16_bf16 v[64:79], v[160:163], v[124:127], v[64:79]
    ds_read_b32 v12, v10
    s_waitcnt lgkmcnt(12)
    v_mfma_f32_32x32x16_bf16 v[80:95], v[160:163], v[128:131], v[80:95]
    s_waitcnt lgkmcnt(9)
    v_mfma_f32_32x32x16_bf16 v[16:31], v[164:167], v[136:139], v[16:31]
    s_waitcnt lgkmcnt(0)
    v_cmp_gt_u32 vcc, 51, v12
    v_add_u32 v15, 1, v15
    ds_write_b32 v1, v15
    v_mfma_f32_32x32x16_bf16 v[32:47], v[164:167], v[140:143], v[32:47]
    s_mov_b32 s61, 51
    s_getpc_b64 s[56:57]
    s_cbranch_vccnz common_slow
    ds_read_b128 v[160:163], v2 offset:32768
    ds_read_b64_tr_b16 v[112:113], v6 offset:24576
    ds_read_b64_tr_b16 v[114:115], v6 offset:25856
    ds_read_b64_tr_b16 v[116:117], v6 offset:24640
    v_mfma_f32_32x32x16_bf16 v[48:63], v[164:167], v[144:147], v[48:63]
    ds_read_b64_tr_b16 v[118:119], v6 offset:25920
    ds_read_b64_tr_b16 v[120:121], v6 offset:24704
    ds_read_b64_tr_b16 v[122:123], v6 offset:25984
    ds_read_b64_tr_b16 v[124:125], v6 offset:24768
    v_mfma_f32_32x32x16_bf16 v[64:79], v[164:167], v[148:151], v[64:79]
    ds_read_b64_tr_b16 v[126:127], v6 offset:26048
    ds_read_b64_tr_b16 v[128:129], v6 offset:24832
    ds_read_b64_tr_b16 v[130:131], v6 offset:26112
    v_mfma_f32_32x32x16_bf16 v[80:95], v[164:167], v[152:155], v[80:95]
    s_waitcnt lgkmcnt(8)
    v_mfma_f32_32x32x16_bf16 v[16:31], v[160:163], v[112:115], v[16:31]
    v_and_b32 v248, 3, v0
    v_lshlrev_b32 v248, 5, v248
    s_lshl_b32 s47, s43, 7
    s_lshl_b32 s48, s6, 3
    s_add_u32 s47, s47, s48
    s_add_u32 s47, s47, s40
    v_add_u32 v248, s47, v248
    v_lshlrev_b32 v248, 8, v248
    s_lshl_b32 s47, s3, 6
    s_add_u32 s47, s47, 0x300000
pollp_100002:
    buffer_load_dword v250, v248, s[28:31], s47 offen sc1
    s_waitcnt vmcnt(0)
    v_cmp_ne_u32 vcc, s62, v250
    s_add_u32 s63, s63, 64
    s_cmp_gt_u32 s63, 300000
    s_cbranch_scc1 pollp_100002_done
    s_nop 2
    s_cbranch_vccnz pollp_100002
pollp_100002_done:
    s_add_u32 s47, s52, 0
    buffer_load_dwordx4 v[96:99], v11, s[28:31], s47 offen offset:0 sc1
    buffer_load_dwordx4 v[100:103], v11, s[28:31], s47 offen offset:1024 sc1
    s_add_u32 s47, s52, 2048
    buffer_load_dwordx4 v[132:135], v11, s[28:31], s47 offen offset:0 sc1
    buffer_load_dwordx4 v[156:159], v11, s[28:31], s47 offen offset:1024 sc1
    ds_read_b128 v[164:167], v3 offset:32768
    ds_read_b64_tr_b16 v[136:137], v6 offset:29696
    ds_read_b64_tr_b16 v[138:139], v6 offset:30976
    ds_read_b64_tr_b16 v[140:141], v6 offset:29760
    s_waitcnt lgkmcnt(10)
    v_mfma_f32_32x32x16_bf16 v[32:47], v[160:163], v[116:119], v[32:47]
    ds_read_b64_tr_b16 v[142:143], v6 offset:31040
    ds_read_b64_tr_b16 v[144:145], v6 offset:29824
    ds_read_b64_tr_b16 v[146:147], v6 offset:31104
    ds_read_b64_tr_b16 v[148:149], v6 offset:29888
    s_waitcnt lgkmcnt(12)
    v_mfma_f32_32x32x16_bf16 v[48:63], v[160:163], v[120:123], v[48:63]
    ds_read_b64_tr_b16 v[150:151], v6 offset:31168
    ds_read_b64_tr_b16 v[152:153], v6 offset:29952
    ds_read_b64_tr_b16 v[154:155], v6 offset:31232
    s_waitcnt lgkmcnt(13)
    v_mfma_f32_32x32x16_bf16 v[64:79], v[160:163], v[124:127], v[64:79]
    s_waitcnt lgkmcnt(11)
    v_mfma_f32_32x32x16_bf16 v[80:95], v[160:163], v[128:131], v[80:95]
    s_waitcnt lgkmcnt(8)
    v_mfma_f32_32x32x16_bf16 v[16:31], v[164:167], v[136:139], v[16:31]
    s_waitcnt lgkmcnt(0)
    v_add_u32 v15, 1, v15
    v_mfma_f32_32x32x16_bf16 v[32:47], v[164:167], v[140:143], v[32:47]
    ds_read_b128 v[160:163], v4 offset:32768
    ds_read_b64_tr_b16 v[112:113], v6 offset:36864
    ds_read_b64_tr_b16 v[114:115], v6 offset:38144
    ds_read_b64_tr_b16 v[116:117], v6 offset:36928
    v_mfma_f32_32x32x16_bf16 v[48:63], v[164:167], v[144:147], v[48:63]
    ds_read_b64_tr_b16 v[118:119], v6 offset:38208
    ds_read_b64_tr_b16 v[120:121], v6 offset:36992
    ds_read_b64_tr_b16 v[122:123], v6 offset:38272
    ds_read_b64_tr_b16 v[124:125], v6 offset:37056
    v_mfma_f32_32x32x16_bf16 v[64:79], v[164:167], v[148:151], v[64:79]
    ds_read_b64_tr_b16 v[126:127], v6 offset:38336
    ds_read_b64_tr_b16 v[128:129], v6 offset:37120
    ds_read_b64_tr_b16 v[130:131], v6 offset:38400
    v_mfma_f32_32x32x16_bf16 v[80:95], v[164:167], v[152:155], v[80:95]
    s_waitcnt lgkmcnt(8)
    v_mfma_f32_32x32x16_bf16 v[16:31], v[160:163], v[112:115], v[16:31]
    ds_read_b128 v[164:167], v5 offset:32768
    ds_read_b64_tr_b16 v[136:137], v6 offset:41984
    ds_read_b64_tr_b16 v[138:139], v6 offset:43264
    ds_read_b64_tr_b16 v[140:141], v6 offset:42048
    s_waitcnt lgkmcnt(10)
    v_mfma_f32_32x32x16_bf16 v[32:47], v[160:163], v[116:119], v[32:47]
    ds_read_b64_tr_b16 v[142:143], v6 offset:43328
    ds_read_b64_tr_b16 v[144:145], v6 offset:42112
    ds_read_b64_tr_b16 v[146:147], v6 offset:43392
    ds_read_b64_tr_b16 v[148:149], v6 offset:42176
    s_waitcnt lgkmcnt(12)
    v_mfma_f32_32x32x16_bf16 v[48:63], v[160:163], v[120:123], v[48:63]
    ds_read_b64_tr_b16 v[150:151], v6 offset:43456
    ds_read_b64_tr_b16 v[152:153], v6 offset:42240
    ds_read_b64_tr_b16 v[154:155], v6 offset:43520
    s_waitcnt lgkmcnt(13)
    v_mfma_f32_32x32x16_bf16 v[64:79], v[160:163], v[124:127], v[64:79]
    ds_read_b32 v12, v10
    s_waitcnt lgkmcnt(12)
    v_mfma_f32_32x32x16_bf16 v[80:95], v[160:163], v[128:131], v[80:95]
    s_waitcnt lgkmcnt(9)
    v_mfma_f32_32x32x16_bf16 v[16:31], v[164:167], v[136:139], v[16:31]
    s_waitcnt lgkmcnt(0)
    v_cmp_gt_u32 vcc, 54, v12
    v_add_u32 v15, 1, v15
    ds_write_b32 v1, v15
    v_mfma_f32_32x32x16_bf16 v[32:47], v[164:167], v[140:143], v[32:47]
    s_mov_b32 s61, 54
    s_getpc_b64 s[56:57]
    s_cbranch_vccnz common_slow
    ds_read_b128 v[160:163], v2 offset:49152
    ds_read_b64_tr_b16 v[112:113], v8 offset:0
    ds_read_b64_tr_b16 v[114:115], v8 offset:1280
    ds_read_b64_tr_b16 v[116:117], v8 offset:64
    v_mfma_f32_32x32x16_bf16 v[48:63], v[164:167], v[144:147], v[48:63]
    ds_read_b64_tr_b16 v[118:119], v8 offset:1344
    ds_read_b64_tr_b16 v[120:121], v8 offset:128
    ds_read_b64_tr_b16 v[122:123], v8 offset:1408
    ds_read_b64_tr_b16 v[124:125], v8 offset:192
    v_mfma_f32_32x32x16_bf16 v[64:79], v[164:167], v[148:151], v[64:79]
    ds_read_b64_tr_b16 v[126:127], v8 offset:1472
    ds_read_b64_tr_b16 v[128:129], v8 offset:256
    ds_read_b64_tr_b16 v[130:131], v8 offset:1536
    v_mfma_f32_32x32x16_bf16 v[80:95], v[164:167], v[152:155], v[80:95]
    s_nop 7
    s_nop 3
    s_waitcnt vmcnt(0)
    v_mfma_f32_32x32x16_bf16 v[168:183], v[192:195], v[96:99], 0
    v_cvt_pk_bf16_f32 v16, v16, v17
    v_cvt_pk_bf16_f32 v17, v18, v19
    v_cvt_pk_bf16_f32 v18, v20, v21
    v_cvt_pk_bf16_f32 v19, v22, v23
    v_mfma_f32_32x32x16_bf16 v[168:183], v[196:199], v[100:103], v[168:183]
    v_cvt_pk_bf16_f32 v20, v24, v25
    v_cvt_pk_bf16_f32 v21, v26, v27
    v_cvt_pk_bf16_f32 v22, v28, v29
    v_cvt_pk_bf16_f32 v23, v30, v31
    v_mfma_f32_32x32x16_bf16 v[184:199], v[208:211], v[96:99], 0
    v_cvt_pk_bf16_f32 v32, v32, v33
    v_cvt_pk_bf16_f32 v33, v34, v35
    v_cvt_pk_bf16_f32 v34, v36, v37
    v_cvt_pk_bf16_f32 v35, v38, v39
    v_mfma_f32_32x32x16_bf16 v[184:199], v[212:215], v[100:103], v[184:199]
    v_cvt_pk_bf16_f32 v36, v40, v41
    v_cvt_pk_bf16_f32 v37, v42, v43
    v_cvt_pk_bf16_f32 v38, v44, v45
    v_cvt_pk_bf16_f32 v39, v46, v47
    v_mfma_f32_32x32x16_bf16 v[200:215], v[224:227], v[96:99], 0
    v_cvt_pk_bf16_f32 v48, v48, v49
    v_cvt_pk_bf16_f32 v49, v50, v51
    v_cvt_pk_bf16_f32 v50, v52, v53
    v_cvt_pk_bf16_f32 v51, v54, v55
    v_mfma_f32_32x32x16_bf16 v[200:215], v[228:231], v[100:103], v[200:215]
    v_cvt_pk_bf16_f32 v52, v56, v57
    v_cvt_pk_bf16_f32 v53, v58, v59
    v_cvt_pk_bf16_f32 v54, v60, v61
    v_cvt_pk_bf16_f32 v55, v62, v63
    v_mfma_f32_32x32x16_bf16 v[216:231], v[240:243], v[96:99], 0
    v_cvt_pk_bf16_f32 v64, v64, v65
    v_cvt_pk_bf16_f32 v65, v66, v67
    v_cvt_pk_bf16_f32 v66, v68, v69
    v_cvt_pk_bf16_f32 v67, v70, v71
    v_mfma_f32_32x32x16_bf16 v[216:231], v[244:247], v[100:103], v[216:231]
    v_cvt_pk_bf16_f32 v68, v72, v73
    v_cvt_pk_bf16_f32 v69, v74, v75
    v_cvt_pk_bf16_f32 v70, v76, v77
    v_cvt_pk_bf16_f32 v71, v78, v79
    v_mfma_f32_32x32x16_bf16 v[232:247], v[104:107], v[96:99], 0
    v_cvt_pk_bf16_f32 v80, v80, v81
    v_cvt_pk_bf16_f32 v81, v82, v83
    v_cvt_pk_bf16_f32 v82, v84, v85
    v_cvt_pk_bf16_f32 v83, v86, v87
    v_mfma_f32_32x32x16_bf16 v[232:247], v[108:111], v[100:103], v[232:247]
    v_cvt_pk_bf16_f32 v84, v88, v89
    v_cvt_pk_bf16_f32 v85, v90, v91
    v_cvt_pk_bf16_f32 v86, v92, v93
    v_cvt_pk_bf16_f32 v87, v94, v95
    s_nop 1
    v_mfma_f32_32x32x16_bf16 v[168:183], v[16:19], v[132:135], v[168:183]
    v_mfma_f32_32x32x16_bf16 v[168:183], v[20:23], v[156:159], v[168:183]
    v_mfma_f32_32x32x16_bf16 v[184:199], v[32:35], v[132:135], v[184:199]
    v_mfma_f32_32x32x16_bf16 v[184:199], v[36:39], v[156:159], v[184:199]
    v_mfma_f32_32x32x16_bf16 v[200:215], v[48:51], v[132:135], v[200:215]
    v_mfma_f32_32x32x16_bf16 v[200:215], v[52:55], v[156:159], v[200:215]
    v_mfma_f32_32x32x16_bf16 v[216:231], v[64:67], v[132:135], v[216:231]
    v_mfma_f32_32x32x16_bf16 v[216:231], v[68:71], v[156:159], v[216:231]
    v_mfma_f32_32x32x16_bf16 v[232:247], v[80:83], v[132:135], v[232:247]
    v_mfma_f32_32x32x16_bf16 v[232:247], v[84:87], v[156:159], v[232:247]
    s_waitcnt lgkmcnt(8)
    v_mfma_f32_32x32x16_bf16 v[16:31], v[160:163], v[112:115], 0
    ds_read_b128 v[164:167], v3 offset:49152
    ds_read_b64_tr_b16 v[136:137], v8 offset:5120
    ds_read_b64_tr_b16 v[138:139], v8 offset:6400
    ds_read_b64_tr_b16 v[140:141], v8 offset:5184
    s_waitcnt lgkmcnt(10)
    v_mfma_f32_32x32x16_bf16 v[32:47], v[160:163], v[116:119], 0
    ds_read_b64_tr_b16 v[142:143], v8 offset:6464
    ds_read_b64_tr_b16 v[144:145], v8 offset:5248
    ds_read_b64_tr_b16 v[146:147], v8 offset:6528
    ds_read_b64_tr_b16 v[148:149], v8 offset:5312
    s_waitcnt lgkmcnt(12)
    v_mfma_f32_32x32x16_bf16 v[48:63], v[160:163], v[120:123], 0
    ds_read_b64_tr_b16 v[150:151], v8 offset:6592
    ds_read_b64_tr_b16 v[152:153], v8 offset:5376
    ds_read_b64_tr_b16 v[154:155], v8 offset:6656
    s_waitcnt lgkmcnt(13)
    v_mfma_f32_32x32x16_bf16 v[64:79], v[160:163], v[124:127], 0
    s_waitcnt lgkmcnt(11)
    v_mfma_f32_32x32x16_bf16 v[80:95], v[160:163], v[128:131], 0
    s_waitcnt lgkmcnt(8)
    v_mfma_f32_32x32x16_bf16 v[16:31], v[164:167], v[136:139], v[16:31]
    s_waitcnt lgkmcnt(0)
    v_add_u32 v15, 1, v15
    v_mfma_f32_32x32x16_bf16 v[32:47], v[164:167], v[140:143], v[32:47]
    ds_read_b128 v[160:163], v4 offset:49152
    ds_read_b64_tr_b16 v[112:113], v8 offset:12288
    ds_read_b64_tr_b16 v[114:115], v8 offset:13568
    ds_read_b64_tr_b16 v[116:117], v8 offset:12352
    v_mfma_f32_32x32x16_bf16 v[48:63], v[164:167], v[144:147], v[48:63]
    ds_read_b64_tr_b16 v[118:119], v8 offset:13632
    ds_read_b64_tr_b16 v[120:121], v8 offset:12416
    ds_read_b64_tr_b16 v[122:123], v8 offset:13696
    ds_read_b64_tr_b16 v[124:125], v8 offset:12480
    v_mfma_f32_32x32x16_bf16 v[64:79], v[164:167], v[148:151], v[64:79]
    ds_read_b64_tr_b16 v[126:127], v8 offset:13760
    ds_read_b64_tr_b16 v[128:129], v8 offset:12544
    ds_read_b64_tr_b16 v[130:131], v8 offset:13824
    v_mfma_f32_32x32x16_bf16 v[80:95], v[164:167], v[152:155], v[80:95]
    s_waitcnt lgkmcnt(8)
    v_mfma_f32_32x32x16_bf16 v[16:31], v[160:163], v[112:115], v[16:31]
    ds_read_b128 v[164:167], v5 offset:49152
    ds_read_b64_tr_b16 v[136:137], v8 offset:17408
    ds_read_b64_tr_b16 v[138:139], v8 offset:18688
    ds_read_b64_tr_b16 v[140:141], v8 offset:17472
    s_waitcnt lgkmcnt(10)
    v_mfma_f32_32x32x16_bf16 v[32:47], v[160:163], v[116:119], v[32:47]
    ds_read_b64_tr_b16 v[142:143], v8 offset:18752
    ds_read_b64_tr_b16 v[144:145], v8 offset:17536
    ds_read_b64_tr_b16 v[146:147], v8 offset:18816
    ds_read_b64_tr_b16 v[148:149], v8 offset:17600
    s_waitcnt lgkmcnt(12)
    v_mfma_f32_32x32x16_bf16 v[48:63], v[160:163], v[120:123], v[48:63]
    ds_read_b64_tr_b16 v[150:151], v8 offset:18880
    ds_read_b64_tr_b16 v[152:153], v8 offset:17664
    ds_read_b64_tr_b16 v[154:155], v8 offset:18944
    s_waitcnt lgkmcnt(13)
    v_mfma_f32_32x32x16_bf16 v[64:79], v[160:163], v[124:127], v[64:79]
    ds_read_b32 v12, v10
    s_waitcnt lgkmcnt(12)
    v_mfma_f32_32x32x16_bf16 v[80:95], v[160:163], v[128:131], v[80:95]
    s_waitcnt lgkmcnt(9)
    v_mfma_f32_32x32x16_bf16 v[16:31], v[164:167], v[136:139], v[16:31]
    s_waitcnt lgkmcnt(0)
    v_cmp_gt_u32 vcc, 57, v12
    v_add_u32 v15, 1, v15
    ds_write_b32 v1, v15
    v_mfma_f32_32x32x16_bf16 v[32:47], v[164:167], v[140:143], v[32:47]
    s_mov_b32 s61, 57
    s_getpc_b64 s[56:57]
    s_cbranch_vccnz common_slow
    ds_read_b128 v[160:163], v2 offset:0
    ds_read_b64_tr_b16 v[112:113], v8 offset:24576
    ds_read_b64_tr_b16 v[114:115], v8 offset:25856
    ds_read_b64_tr_b16 v[116:117], v8 offset:24640
    v_mfma_f32_32x32x16_bf16 v[48:63], v[164:167], v[144:147], v[48:63]
    ds_read_b64_tr_b16 v[118:119], v8 offset:25920
    ds_read_b64_tr_b16 v[120:121], v8 offset:24704
    ds_read_b64_tr_b16 v[122:123], v8 offset:25984
    ds_read_b64_tr_b16 v[124:125], v8 offset:24768
    v_mfma_f32_32x32x16_bf16 v[64:79], v[164:167], v[148:151], v[64:79]
    ds_read_b64_tr_b16 v[126:127], v8 offset:26048
    ds_read_b64_tr_b16 v[128:129], v8 offset:24832
    ds_read_b64_tr_b16 v[130:131], v8 offset:26112
    v_mfma_f32_32x32x16_bf16 v[80:95], v[164:167], v[152:155], v[80:95]
    s_waitcnt lgkmcnt(8)
    v_mfma_f32_32x32x16_bf16 v[16:31], v[160:163], v[112:115], v[16:31]
    s_add_u32 s47, s52, 4096
    buffer_load_dwordx4 v[96:99], v11, s[28:31], s47 offen offset:0 sc1
    buffer_load_dwordx4 v[100:103], v11, s[28:31], s47 offen offset:1024 sc1
    ds_read_b128 v[164:167], v3 offset:0
    ds_read_b64_tr_b16 v[136:137], v8 offset:29696
    ds_read_b64_tr_b16 v[138:139], v8 offset:30976
    ds_read_b64_tr_b16 v[140:141], v8 offset:29760
    s_waitcnt lgkmcnt(10)
    v_mfma_f32_32x32x16_bf16 v[32:47], v[160:163], v[116:119], v[32:47]
    ds_read_b64_tr_b16 v[142:143], v8 offset:31040
    ds_read_b64_tr_b16 v[144:145], v8 offset:29824
    ds_read_b64_tr_b16 v[146:147], v8 offset:31104
    ds_read_b64_tr_b16 v[148:149], v8 offset:29888
    s_waitcnt lgkmcnt(12)
    v_mfma_f32_32x32x16_bf16 v[48:63], v[160:163], v[120:123], v[48:63]
    ds_read_b64_tr_b16 v[150:151], v8 offset:31168
    ds_read_b64_tr_b16 v[152:153], v8 offset:29952
    ds_read_b64_tr_b16 v[154:155], v8 offset:31232
    s_waitcnt lgkmcnt(13)
    v_mfma_f32_32x32x16_bf16 v[64:79], v[160:163], v[124:127], v[64:79]
    s_waitcnt lgkmcnt(11)
    v_mfma_f32_32x32x16_bf16 v[80:95], v[160:163], v[128:131], v[80:95]
    s_waitcnt lgkmcnt(8)
    v_mfma_f32_32x32x16_bf16 v[16:31], v[164:167], v[136:139], v[16:31]
    s_waitcnt lgkmcnt(0)
    v_add_u32 v15, 1, v15
    v_mfma_f32_32x32x16_bf16 v[32:47], v[164:167], v[140:143], v[32:47]
    ds_read_b128 v[160:163], v4 offset:0
    ds_read_b64_tr_b16 v[112:113], v6 offset:0
    ds_read_b64_tr_b16 v[114:115], v6 offset:1280
    ds_read_b64_tr_b16 v[116:117], v6 offset:64
    v_mfma_f32_32x32x16_bf16 v[48:63], v[164:167], v[144:147], v[48:63]
    ds_read_b64_tr_b16 v[118:119], v6 offset:1344
    ds_read_b64_tr_b16 v[120:121], v6 offset:128
    ds_read_b64_tr_b16 v[122:123], v6 offset:1408
    ds_read_b64_tr_b16 v[124:125], v6 offset:192
    v_mfma_f32_32x32x16_bf16 v[64:79], v[164:167], v[148:151], v[64:79]
    ds_read_b64_tr_b16 v[126:127], v6 offset:1472
    ds_read_b64_tr_b16 v[128:129], v6 offset:256
    ds_read_b64_tr_b16 v[130:131], v6 offset:1536
    v_mfma_f32_32x32x16_bf16 v[80:95], v[164:167], v[152:155], v[80:95]
    s_waitcnt lgkmcnt(8)
    v_mfma_f32_32x32x16_bf16 v[16:31], v[160:163], v[112:115], v[16:31]
    ds_read_b128 v[164:167], v5 offset:0
    ds_read_b64_tr_b16 v[136:137], v6 offset:5120
    ds_read_b64_tr_b16 v[138:139], v6 offset:6400
    ds_read_b64_tr_b16 v[140:141], v6 offset:5184
    s_waitcnt lgkmcnt(10)
    v_mfma_f32_32x32x16_bf16 v[32:47], v[160:163], v[116:119], v[32:47]
    ds_read_b64_tr_b16 v[142:143], v6 offset:6464
    ds_read_b64_tr_b16 v[144:145], v6 offset:5248
    ds_read_b64_tr_b16 v[146:147], v6 offset:6528
    ds_read_b64_tr_b16 v[148:149], v6 offset:5312
    s_waitcnt lgkmcnt(12)
    v_mfma_f32_32x32x16_bf16 v[48:63], v[160:163], v[120:123], v[48:63]
    ds_read_b64_tr_b16 v[150:151], v6 offset:6592
    ds_read_b64_tr_b16 v[152:153], v6 offset:5376
    ds_read_b64_tr_b16 v[154:155], v6 offset:6656
    s_waitcnt lgkmcnt(13)
    v_mfma_f32_32x32x16_bf16 v[64:79], v[160:163], v[124:127], v[64:79]
    ds_read_b32 v12, v10
    s_waitcnt lgkmcnt(12)
    v_mfma_f32_32x32x16_bf16 v[80:95], v[160:163], v[128:131], v[80:95]
    s_waitcnt lgkmcnt(9)
    v_mfma_f32_32x32x16_bf16 v[16:31], v[164:167], v[136:139], v[16:31]
    s_waitcnt lgkmcnt(0)
    v_cmp_gt_u32 vcc, 60, v12
    v_add_u32 v15, 1, v15
    ds_write_b32 v1, v15
    v_mfma_f32_32x32x16_bf16 v[32:47], v[164:167], v[140:143], v[32:47]
    s_mov_b32 s61, 60
    s_getpc_b64 s[56:57]
    s_cbranch_vccnz common_slow
    ds_read_b128 v[160:163], v2 offset:16384
    ds_read_b64_tr_b16 v[112:113], v6 offset:12288
    ds_read_b64_tr_b16 v[114:115], v6 offset:13568
    ds_read_b64_tr_b16 v[116:117], v6 offset:12352
    v_mfma_f32_32x32x16_bf16 v[48:63], v[164:167], v[144:147], v[48:63]
    ds_read_b64_tr_b16 v[118:119], v6 offset:13632
    ds_read_b64_tr_b16 v[120:121], v6 offset:12416
    ds_read_b64_tr_b16 v[122:123], v6 offset:13696
    ds_read_b64_tr_b16 v[124:125], v6 offset:12480
    v_mfma_f32_32x32x16_bf16 v[64:79], v[164:167], v[148:151], v[64:79]
    ds_read_b64_tr_b16 v[126:127], v6 offset:13760
    ds_read_b64_tr_b16 v[128:129], v6 offset:12544
    ds_read_b64_tr_b16 v[130:131], v6 offset:13824
    v_mfma_f32_32x32x16_bf16 v[80:95], v[164:167], v[152:155], v[80:95]
    s_waitcnt lgkmcnt(8)
    v_mfma_f32_32x32x16_bf16 v[16:31], v[160:163], v[112:115], v[16:31]
    ds_read_b128 v[164:167], v3 offset:16384
    ds_read_b64_tr_b16 v[136:137], v6 offset:17408
    ds_read_b64_tr_b16 v[138:139], v6 offset:18688
    ds_read_b64_tr_b16 v[140:141], v6 offset:17472
    s_waitcnt lgkmcnt(10)
    v_mfma_f32_32x32x16_bf16 v[32:47], v[160:163], v[116:119], v[32:47]
    ds_read_b64_tr_b16 v[142:143], v6 offset:18752
    ds_read_b64_tr_b16 v[144:145], v6 offset:17536
    ds_read_b64_tr_b16 v[146:147], v6 offset:18816
    ds_read_b64_tr_b16 v[148:149], v6 offset:17600
    s_waitcnt lgkmcnt(12)
    v_mfma_f32_32x32x16_bf16 v[48:63], v[160:163], v[120:123], v[48:63]
    ds_read_b64_tr_b16 v[150:151], v6 offset:18880
    ds_read_b64_tr_b16 v[152:153], v6 offset:17664
    ds_read_b64_tr_b16 v[154:155], v6 offset:18944
    s_waitcnt lgkmcnt(13)
    v_mfma_f32_32x32x16_bf16 v[64:79], v[160:163], v[124:127], v[64:79]
    s_waitcnt lgkmcnt(11)
    v_mfma_f32_32x32x16_bf16 v[80:95], v[160:163], v[128:131], v[80:95]
    s_waitcnt lgkmcnt(8)
    v_mfma_f32_32x32x16_bf16 v[16:31], v[164:167], v[136:139], v[16:31]
    s_waitcnt lgkmcnt(0)
    v_add_u32 v15, 1, v15
    v_mfma_f32_32x32x16_bf16 v[32:47], v[164:167], v[140:143], v[32:47]
    ds_read_b128 v[160:163], v4 offset:16384
    ds_read_b64_tr_b16 v[112:113], v6 offset:24576
    ds_read_b64_tr_b16 v[114:115], v6 offset:25856
    ds_read_b64_tr_b16 v[116:117], v6 offset:24640
    v_mfma_f32_32x32x16_bf16 v[48:63], v[164:167], v[144:147], v[48:63]
    ds_read_b64_tr_b16 v[118:119], v6 offset:25920
    ds_read_b64_tr_b16 v[120:121], v6 offset:24704
    ds_read_b64_tr_b16 v[122:123], v6 offset:25984
    ds_read_b64_tr_b16 v[124:125], v6 offset:24768
    v_mfma_f32_32x32x16_bf16 v[64:79], v[164:167], v[148:151], v[64:79]
    ds_read_b64_tr_b16 v[126:127], v6 offset:26048
    ds_read_b64_tr_b16 v[128:129], v6 offset:24832
    ds_read_b64_tr_b16 v[130:131], v6 offset:26112
    v_mfma_f32_32x32x16_bf16 v[80:95], v[164:167], v[152:155], v[80:95]
    s_waitcnt lgkmcnt(8)
    v_mfma_f32_32x32x16_bf16 v[16:31], v[160:163], v[112:115], v[16:31]
    ds_read_b128 v[164:167], v5 offset:16384
    ds_read_b64_tr_b16 v[136:137], v6 offset:29696
    ds_read_b64_tr_b16 v[138:139], v6 offset:30976
    ds_read_b64_tr_b16 v[140:141], v6 offset:29760
    s_waitcnt lgkmcnt(10)
    v_mfma_f32_32x32x16_bf16 v[32:47], v[160:163], v[116:119], v[32:47]
    ds_read_b64_tr_b16 v[142:143], v6 offset:31040
    ds_read_b64_tr_b16 v[144:145], v6 offset:29824
    ds_read_b64_tr_b16 v[146:147], v6 offset:31104
    ds_read_b64_tr_b16 v[148:149], v6 offset:29888
    s_waitcnt lgkmcnt(12)
    v_mfma_f32_32x32x16_bf16 v[48:63], v[160:163], v[120:123], v[48:63]
    ds_read_b64_tr_b16 v[150:151], v6 offset:31168
    ds_read_b64_tr_b16 v[152:153], v6 offset:29952
    ds_read_b64_tr_b16 v[154:155], v6 offset:31232
    s_waitcnt lgkmcnt(13)
    v_mfma_f32_32x32x16_bf16 v[64:79], v[160:163], v[124:127], v[64:79]
    ds_read_b32 v12, v10
    s_waitcnt lgkmcnt(12)
    v_mfma_f32_32x32x16_bf16 v[80:95], v[160:163], v[128:131], v[80:95]
    s_waitcnt lgkmcnt(9)
    v_mfma_f32_32x32x16_bf16 v[16:31], v[164:167], v[136:139], v[16:31]
    s_waitcnt lgkmcnt(0)
    v_cmp_gt_u32 vcc, 63, v12
    v_add_u32 v15, 1, v15
    ds_write_b32 v1, v15
    v_mfma_f32_32x32x16_bf16 v[32:47], v[164:167], v[140:143], v[32:47]
    s_mov_b32 s61, 63
    s_getpc_b64 s[56:57]
    s_cbranch_vccnz common_slow
    ds_read_b128 v[160:163], v2 offset:32768
    ds_read_b64_tr_b16 v[112:113], v6 offset:36864
    ds_read_b64_tr_b16 v[114:115], v6 offset:38144
    ds_read_b64_tr_b16 v[116:117], v6 offset:36928
    v_mfma_f32_32x32x16_bf16 v[48:63], v[164:167], v[144:147], v[48:63]
    ds_read_b64_tr_b16 v[118:119], v6 offset:38208
    ds_read_b64_tr_b16 v[120:121], v6 offset:36992
    ds_read_b64_tr_b16 v[122:123], v6 offset:38272
    ds_read_b64_tr_b16 v[124:125], v6 offset:37056
    v_mfma_f32_32x32x16_bf16 v[64:79], v[164:167], v[148:151], v[64:79]
    ds_read_b64_tr_b16 v[126:127], v6 offset:38336
    ds_read_b64_tr_b16 v[128:129], v6 offset:37120
    ds_read_b64_tr_b16 v[130:131], v6 offset:38400
    v_mfma_f32_32x32x16_bf16 v[80:95], v[164:167], v[152:155], v[80:95]
    s_nop 7
    s_nop 3
    s_waitcnt vmcnt(0)
    v_cvt_pk_bf16_f32 v16, v16, v17
    v_cvt_pk_bf16_f32 v17, v18, v19
    v_cvt_pk_bf16_f32 v18, v20, v21
    v_cvt_pk_bf16_f32 v19, v22, v23
    v_cvt_pk_bf16_f32 v20, v24, v25
    v_cvt_pk_bf16_f32 v21, v26, v27
    v_cvt_pk_bf16_f32 v22, v28, v29
    v_cvt_pk_bf16_f32 v23, v30, v31
    s_nop 1
    v_mfma_f32_32x32x16_bf16 v[168:183], v[16:19], v[96:99], v[168:183]
    v_cvt_pk_bf16_f32 v32, v32, v33
    v_cvt_pk_bf16_f32 v33, v34, v35
    v_cvt_pk_bf16_f32 v34, v36, v37
    v_cvt_pk_bf16_f32 v35, v38, v39
    v_mfma_f32_32x32x16_bf16 v[168:183], v[20:23], v[100:103], v[168:183]
    v_cvt_pk_bf16_f32 v36, v40, v41
    v_cvt_pk_bf16_f32 v37, v42, v43
    v_cvt_pk_bf16_f32 v38, v44, v45
    v_cvt_pk_bf16_f32 v39, v46, v47
    s_nop 1
    v_mfma_f32_32x32x16_bf16 v[184:199], v[32:35], v[96:99], v[184:199]
    v_cvt_pk_bf16_f32 v48, v48, v49
    v_cvt_pk_bf16_f32 v49, v50, v51
    v_cvt_pk_bf16_f32 v50, v52, v53
    v_cvt_pk_bf16_f32 v51, v54, v55
    v_mfma_f32_32x32x16_bf16 v[184:199], v[36:39], v[100:103], v[184:199]
    v_cvt_pk_bf16_f32 v52, v56, v57
    v_cvt_pk_bf16_f32 v53, v58, v59
    v_cvt_pk_bf16_f32 v54, v60, v61
    v_cvt_pk_bf16_f32 v55, v62, v63
    s_nop 1
    v_mfma_f32_32x32x16_bf16 v[200:215], v[48:51], v[96:99], v[200:215]
    v_cvt_pk_bf16_f32 v64, v64, v65
    v_cvt_pk_bf16_f32 v65, v66, v67
    v_cvt_pk_bf16_f32 v66, v68, v69
    v_cvt_pk_bf16_f32 v67, v70, v71
    v_mfma_f32_32x32x16_bf16 v[200:215], v[52:55], v[100:103], v[200:215]
    v_cvt_pk_bf16_f32 v68, v72, v73
    v_cvt_pk_bf16_f32 v69, v74, v75
    v_cvt_pk_bf16_f32 v70, v76, v77
    v_cvt_pk_bf16_f32 v71, v78, v79
    s_nop 1
    v_mfma_f32_32x32x16_bf16 v[216:231], v[64:67], v[96:99], v[216:231]
    v_cvt_pk_bf16_f32 v80, v80, v81
    v_cvt_pk_bf16_f32 v81, v82, v83
    v_cvt_pk_bf16_f32 v82, v84, v85
    v_cvt_pk_bf16_f32 v83, v86, v87
    v_mfma_f32_32x32x16_bf16 v[216:231], v[68:71], v[100:103], v[216:231]
    v_cvt_pk_bf16_f32 v84, v88, v89
    v_cvt_pk_bf16_f32 v85, v90, v91
    v_cvt_pk_bf16_f32 v86, v92, v93
    v_cvt_pk_bf16_f32 v87, v94, v95
    s_nop 1
    v_mfma_f32_32x32x16_bf16 v[232:247], v[80:83], v[96:99], v[232:247]
    v_mfma_f32_32x32x16_bf16 v[232:247], v[84:87], v[100:103], v[232:247]
    s_waitcnt lgkmcnt(8)
    v_mfma_f32_32x32x16_bf16 v[16:31], v[160:163], v[112:115], 0
    ds_read_b128 v[164:167], v3 offset:32768
    ds_read_b64_tr_b16 v[136:137], v6 offset:41984
    ds_read_b64_tr_b16 v[138:139], v6 offset:43264
    ds_read_b64_tr_b16 v[140:141], v6 offset:42048
    s_waitcnt lgkmcnt(10)
    v_mfma_f32_32x32x16_bf16 v[32:47], v[160:163], v[116:119], 0
    ds_read_b64_tr_b16 v[142:143], v6 offset:43328
    ds_read_b64_tr_b16 v[144:145], v6 offset:42112
    ds_read_b64_tr_b16 v[146:147], v6 offset:43392
    ds_read_b64_tr_b16 v[148:149], v6 offset:42176
    s_waitcnt lgkmcnt(12)
    v_mfma_f32_32x32x16_bf16 v[48:63], v[160:163], v[120:123], 0
    ds_read_b64_tr_b16 v[150:151], v6 offset:43456
    ds_read_b64_tr_b16 v[152:153], v6 offset:42240
    ds_read_b64_tr_b16 v[154:155], v6 offset:43520
    s_waitcnt lgkmcnt(13)
    v_mfma_f32_32x32x16_bf16 v[64:79], v[160:163], v[124:127], 0
    s_waitcnt lgkmcnt(11)
    v_mfma_f32_32x32x16_bf16 v[80:95], v[160:163], v[128:131], 0
    s_waitcnt lgkmcnt(8)
    v_mfma_f32_32x32x16_bf16 v[16:31], v[164:167], v[136:139], v[16:31]
    s_waitcnt lgkmcnt(0)
    v_add_u32 v15, 1, v15
    v_mfma_f32_32x32x16_bf16 v[32:47], v[164:167], v[140:143], v[32:47]
    ds_read_b128 v[160:163], v4 offset:32768
    ds_read_b64_tr_b16 v[112:113], v8 offset:0
    ds_read_b64_tr_b16 v[114:115], v8 offset:1280
    ds_read_b64_tr_b16 v[116:117], v8 offset:64
    v_mfma_f32_32x32x16_bf16 v[48:63], v[164:167], v[144:147], v[48:63]
    ds_read_b64_tr_b16 v[118:119], v8 offset:1344
    ds_read_b64_tr_b16 v[120:121], v8 offset:128
    ds_read_b64_tr_b16 v[122:123], v8 offset:1408
    ds_read_b64_tr_b16 v[124:125], v8 offset:192
    v_mfma_f32_32x32x16_bf16 v[64:79], v[164:167], v[148:151], v[64:79]
    ds_read_b64_tr_b16 v[126:127], v8 offset:1472
    ds_read_b64_tr_b16 v[128:129], v8 offset:256
    ds_read_b64_tr_b16 v[130:131], v8 offset:1536
    v_mfma_f32_32x32x16_bf16 v[80:95], v[164:167], v[152:155], v[80:95]
    s_waitcnt lgkmcnt(8)
    v_mfma_f32_32x32x16_bf16 v[16:31], v[160:163], v[112:115], v[16:31]
    ds_read_b128 v[164:167], v5 offset:32768
    ds_read_b64_tr_b16 v[136:137], v8 offset:5120
    ds_read_b64_tr_b16 v[138:139], v8 offset:6400
    ds_read_b64_tr_b16 v[140:141], v8 offset:5184
    s_waitcnt lgkmcnt(10)
    v_mfma_f32_32x32x16_bf16 v[32:47], v[160:163], v[116:119], v[32:47]
    ds_read_b64_tr_b16 v[142:143], v8 offset:6464
    ds_read_b64_tr_b16 v[144:145], v8 offset:5248
    ds_read_b64_tr_b16 v[146:147], v8 offset:6528
    ds_read_b64_tr_b16 v[148:149], v8 offset:5312
    s_waitcnt lgkmcnt(12)
    v_mfma_f32_32x32x16_bf16 v[48:63], v[160:163], v[120:123], v[48:63]
    ds_read_b64_tr_b16 v[150:151], v8 offset:6592
    ds_read_b64_tr_b16 v[152:153], v8 offset:5376
    ds_read_b64_tr_b16 v[154:155], v8 offset:6656
    s_waitcnt lgkmcnt(13)
    v_mfma_f32_32x32x16_bf16 v[64:79], v[160:163], v[124:127], v[64:79]
    ds_read_b32 v12, v10
    s_waitcnt lgkmcnt(12)
    v_mfma_f32_32x32x16_bf16 v[80:95], v[160:163], v[128:131], v[80:95]
    s_waitcnt lgkmcnt(9)
    v_mfma_f32_32x32x16_bf16 v[16:31], v[164:167], v[136:139], v[16:31]
    s_waitcnt lgkmcnt(0)
    v_cmp_gt_u32 vcc, 66, v12
    v_add_u32 v15, 1, v15
    ds_write_b32 v1, v15
    v_mfma_f32_32x32x16_bf16 v[32:47], v[164:167], v[140:143], v[32:47]
    s_mov_b32 s61, 66
    s_getpc_b64 s[56:57]
    s_cbranch_vccnz common_slow
    ds_read_b128 v[160:163], v2 offset:49152
    ds_read_b64_tr_b16 v[112:113], v8 offset:12288
    ds_read_b64_tr_b16 v[114:115], v8 offset:13568
    ds_read_b64_tr_b16 v[116:117], v8 offset:12352
    v_mfma_f32_32x32x16_bf16 v[48:63], v[164:167], v[144:147], v[48:63]
    ds_read_b64_tr_b16 v[118:119], v8 offset:13632
    ds_read_b64_tr_b16 v[120:121], v8 offset:12416
    ds_read_b64_tr_b16 v[122:123], v8 offset:13696
    ds_read_b64_tr_b16 v[124:125], v8 offset:12480
    v_mfma_f32_32x32x16_bf16 v[64:79], v[164:167], v[148:151], v[64:79]
    ds_read_b64_tr_b16 v[126:127], v8 offset:13760
    ds_read_b64_tr_b16 v[128:129], v8 offset:12544
    ds_read_b64_tr_b16 v[130:131], v8 offset:13824
    v_mfma_f32_32x32x16_bf16 v[80:95], v[164:167], v[152:155], v[80:95]
    s_waitcnt lgkmcnt(8)
    v_mfma_f32_32x32x16_bf16 v[16:31], v[160:163], v[112:115], v[16:31]
    s_add_u32 s47, s52, 6144
    buffer_load_dwordx4 v[132:135], v11, s[28:31], s47 offen offset:0 sc1
    buffer_load_dwordx4 v[156:159], v11, s[28:31], s47 offen offset:1024 sc1
    ds_read_b128 v[164:167], v3 offset:49152
    ds_read_b64_tr_b16 v[136:137], v8 offset:17408
    ds_read_b64_tr_b16 v[138:139], v8 offset:18688
    ds_read_b64_tr_b16 v[140:141], v8 offset:17472
    s_waitcnt lgkmcnt(10)
    v_mfma_f32_32x32x16_bf16 v[32:47], v[160:163], v[116:119], v[32:47]
    ds_read_b64_tr_b16 v[142:143], v8 offset:18752
    ds_read_b64_tr_b16 v[144:145], v8 offset:17536
    ds_read_b64_tr_b16 v[146:147], v8 offset:18816
    ds_read_b64_tr_b16 v[148:149], v8 offset:17600
    s_waitcnt lgkmcnt(12)
    v_mfma_f32_32x32x16_bf16 v[48:63], v[160:163], v[120:123], v[48:63]
    ds_read_b64_tr_b16 v[150:151], v8 offset:18880
    ds_read_b64_tr_b16 v[152:153], v8 offset:17664
    ds_read_b64_tr_b16 v[154:155], v8 offset:18944
    s_waitcnt lgkmcnt(13)
    v_mfma_f32_32x32x16_bf16 v[64:79], v[160:163], v[124:127], v[64:79]
    s_waitcnt lgkmcnt(11)
    v_mfma_f32_32x32x16_bf16 v[80:95], v[160:163], v[128:131], v[80:95]
    s_waitcnt lgkmcnt(8)
    v_mfma_f32_32x32x16_bf16 v[16:31], v[164:167], v[136:139], v[16:31]
    s_waitcnt lgkmcnt(0)
    v_add_u32 v15, 1, v15
    v_mfma_f32_32x32x16_bf16 v[32:47], v[164:167], v[140:143], v[32:47]
    ds_read_b128 v[160:163], v4 offset:49152
    ds_read_b64_tr_b16 v[112:113], v8 offset:24576
    ds_read_b64_tr_b16 v[114:115], v8 offset:25856
    ds_read_b64_tr_b16 v[116:117], v8 offset:24640
    v_mfma_f32_32x32x16_bf16 v[48:63], v[164:167], v[144:147], v[48:63]
    ds_read_b64_tr_b16 v[118:119], v8 offset:25920
    ds_read_b64_tr_b16 v[120:121], v8 offset:24704
    ds_read_b64_tr_b16 v[122:123], v8 offset:25984
    ds_read_b64_tr_b16 v[124:125], v8 offset:24768
    v_mfma_f32_32x32x16_bf16 v[64:79], v[164:167], v[148:151], v[64:79]
    ds_read_b64_tr_b16 v[126:127], v8 offset:26048
    ds_read_b64_tr_b16 v[128:129], v8 offset:24832
    ds_read_b64_tr_b16 v[130:131], v8 offset:26112
    v_mfma_f32_32x32x16_bf16 v[80:95], v[164:167], v[152:155], v[80:95]
    s_waitcnt lgkmcnt(8)
    v_mfma_f32_32x32x16_bf16 v[16:31], v[160:163], v[112:115], v[16:31]
    ds_read_b128 v[164:167], v5 offset:49152
    ds_read_b64_tr_b16 v[136:137], v8 offset:29696
    ds_read_b64_tr_b16 v[138:139], v8 offset:30976
    ds_read_b64_tr_b16 v[140:141], v8 offset:29760
    s_waitcnt lgkmcnt(10)
    v_mfma_f32_32x32x16_bf16 v[32:47], v[160:163], v[116:119], v[32:47]
    ds_read_b64_tr_b16 v[142:143], v8 offset:31040
    ds_read_b64_tr_b16 v[144:145], v8 offset:29824
    ds_read_b64_tr_b16 v[146:147], v8 offset:31104
    ds_read_b64_tr_b16 v[148:149], v8 offset:29888
    s_waitcnt lgkmcnt(12)
    v_mfma_f32_32x32x16_bf16 v[48:63], v[160:163], v[120:123], v[48:63]
    ds_read_b64_tr_b16 v[150:151], v8 offset:31168
    ds_read_b64_tr_b16 v[152:153], v8 offset:29952
    ds_read_b64_tr_b16 v[154:155], v8 offset:31232
    s_waitcnt lgkmcnt(13)
    v_mfma_f32_32x32x16_bf16 v[64:79], v[160:163], v[124:127], v[64:79]
    ds_read_b32 v12, v10
    s_waitcnt lgkmcnt(12)
    v_mfma_f32_32x32x16_bf16 v[80:95], v[160:163], v[128:131], v[80:95]
    s_waitcnt lgkmcnt(9)
    v_mfma_f32_32x32x16_bf16 v[16:31], v[164:167], v[136:139], v[16:31]
    s_waitcnt lgkmcnt(0)
    v_cmp_gt_u32 vcc, 69, v12
    v_add_u32 v15, 1, v15
    ds_write_b32 v1, v15
    v_mfma_f32_32x32x16_bf16 v[32:47], v[164:167], v[140:143], v[32:47]
    s_mov_b32 s61, 69
    s_getpc_b64 s[56:57]
    s_cbranch_vccnz common_slow
    ds_read_b128 v[160:163], v2 offset:0
    ds_read_b64_tr_b16 v[112:113], v6 offset:0
    ds_read_b64_tr_b16 v[114:115], v6 offset:1280
    ds_read_b64_tr_b16 v[116:117], v6 offset:64
    v_mfma_f32_32x32x16_bf16 v[48:63], v[164:167], v[144:147], v[48:63]
    ds_read_b64_tr_b16 v[118:119], v6 offset:1344
    ds_read_b64_tr_b16 v[120:121], v6 offset:128
    ds_read_b64_tr_b16 v[122:123], v6 offset:1408
    ds_read_b64_tr_b16 v[124:125], v6 offset:192
    v_mfma_f32_32x32x16_bf16 v[64:79], v[164:167], v[148:151], v[64:79]
    ds_read_b64_tr_b16 v[126:127], v6 offset:1472
    ds_read_b64_tr_b16 v[128:129], v6 offset:256
    ds_read_b64_tr_b16 v[130:131], v6 offset:1536
    v_mfma_f32_32x32x16_bf16 v[80:95], v[164:167], v[152:155], v[80:95]
    s_waitcnt lgkmcnt(8)
    v_mfma_f32_32x32x16_bf16 v[16:31], v[160:163], v[112:115], v[16:31]
    ds_read_b128 v[164:167], v3 offset:0
    ds_read_b64_tr_b16 v[136:137], v6 offset:5120
    ds_read_b64_tr_b16 v[138:139], v6 offset:6400
    ds_read_b64_tr_b16 v[140:141], v6 offset:5184
    s_waitcnt lgkmcnt(10)
    v_mfma_f32_32x32x16_bf16 v[32:47], v[160:163], v[116:119], v[32:47]
    ds_read_b64_tr_b16 v[142:143], v6 offset:6464
    ds_read_b64_tr_b16 v[144:145], v6 offset:5248
    ds_read_b64_tr_b16 v[146:147], v6 offset:6528
    ds_read_b64_tr_b16 v[148:149], v6 offset:5312
    s_waitcnt lgkmcnt(12)
    v_mfma_f32_32x32x16_bf16 v[48:63], v[160:163], v[120:123], v[48:63]
    ds_read_b64_tr_b16 v[150:151], v6 offset:6592
    ds_read_b64_tr_b16 v[152:153], v6 offset:5376
    ds_read_b64_tr_b16 v[154:155], v6 offset:6656
    s_waitcnt lgkmcnt(13)
    v_mfma_f32_32x32x16_bf16 v[64:79], v[160:163], v[124:127], v[64:79]
    s_waitcnt lgkmcnt(11)
    v_mfma_f32_32x32x16_bf16 v[80:95], v[160:163], v[128:131], v[80:95]
    s_waitcnt lgkmcnt(8)
    v_mfma_f32_32x32x16_bf16 v[16:31], v[164:167], v[136:139], v[16:31]
    s_waitcnt lgkmcnt(0)
    v_add_u32 v15, 1, v15
    v_mfma_f32_32x32x16_bf16 v[32:47], v[164:167], v[140:143], v[32:47]
    ds_read_b128 v[160:163], v4 offset:0
    ds_read_b64_tr_b16 v[112:113], v6 offset:12288
    ds_read_b64_tr_b16 v[114:115], v6 offset:13568
    ds_read_b64_tr_b16 v[116:117], v6 offset:12352
    v_mfma_f32_32x32x16_bf16 v[48:63], v[164:167], v[144:147], v[48:63]
    ds_read_b64_tr_b16 v[118:119], v6 offset:13632
    ds_read_b64_tr_b16 v[120:121], v6 offset:12416
    ds_read_b64_tr_b16 v[122:123], v6 offset:13696
    ds_read_b64_tr_b16 v[124:125], v6 offset:12480
    v_mfma_f32_32x32x16_bf16 v[64:79], v[164:167], v[148:151], v[64:79]
    ds_read_b64_tr_b16 v[126:127], v6 offset:13760
    ds_read_b64_tr_b16 v[128:129], v6 offset:12544
    ds_read_b64_tr_b16 v[130:131], v6 offset:13824
    v_mfma_f32_32x32x16_bf16 v[80:95], v[164:167], v[152:155], v[80:95]
    s_waitcnt lgkmcnt(8)
    v_mfma_f32_32x32x16_bf16 v[16:31], v[160:163], v[112:115], v[16:31]
    ds_read_b128 v[164:167], v5 offset:0
    ds_read_b64_tr_b16 v[136:137], v6 offset:17408
    ds_read_b64_tr_b16 v[138:139], v6 offset:18688
    ds_read_b64_tr_b16 v[140:141], v6 offset:17472
    s_waitcnt lgkmcnt(10)
    v_mfma_f32_32x32x16_bf16 v[32:47], v[160:163], v[116:119], v[32:47]
    ds_read_b64_tr_b16 v[142:143], v6 offset:18752
    ds_read_b64_tr_b16 v[144:145], v6 offset:17536
    ds_read_b64_tr_b16 v[146:147], v6 offset:18816
    ds_read_b64_tr_b16 v[148:149], v6 offset:17600
    s_waitcnt lgkmcnt(12)
    v_mfma_f32_32x32x16_bf16 v[48:63], v[160:163], v[120:123], v[48:63]
    ds_read_b64_tr_b16 v[150:151], v6 offset:18880
    ds_read_b64_tr_b16 v[152:153], v6 offset:17664
    ds_read_b64_tr_b16 v[154:155], v6 offset:18944
    s_waitcnt lgkmcnt(13)
    v_mfma_f32_32x32x16_bf16 v[64:79], v[160:163], v[124:127], v[64:79]
    s_waitcnt lgkmcnt(11)
    v_mfma_f32_32x32x16_bf16 v[80:95], v[160:163], v[128:131], v[80:95]
    s_waitcnt lgkmcnt(8)
    v_mfma_f32_32x32x16_bf16 v[16:31], v[164:167], v[136:139], v[16:31]
    s_waitcnt lgkmcnt(6)
    v_mfma_f32_32x32x16_bf16 v[32:47], v[164:167], v[140:143], v[32:47]
    s_waitcnt lgkmcnt(0)
    v_add_u32 v15, 1, v15
    ds_write_b32 v1, v15
    v_mfma_f32_32x32x16_bf16 v[48:63], v[164:167], v[144:147], v[48:63]
    v_mfma_f32_32x32x16_bf16 v[64:79], v[164:167], v[148:151], v[64:79]
    v_mfma_f32_32x32x16_bf16 v[80:95], v[164:167], v[152:155], v[80:95]
    s_nop 7
    s_nop 3
    s_waitcnt vmcnt(0)
    v_cvt_pk_bf16_f32 v16, v16, v17
    v_cvt_pk_bf16_f32 v17, v18, v19
    v_cvt_pk_bf16_f32 v18, v20, v21
    v_cvt_pk_bf16_f32 v19, v22, v23
    v_cvt_pk_bf16_f32 v20, v24, v25
    v_cvt_pk_bf16_f32 v21, v26, v27
    v_cvt_pk_bf16_f32 v22, v28, v29
    v_cvt_pk_bf16_f32 v23, v30, v31
    s_nop 1
    v_mfma_f32_32x32x16_bf16 v[168:183], v[16:19], v[132:135], v[168:183]
    v_cvt_pk_bf16_f32 v32, v32, v33
    v_cvt_pk_bf16_f32 v33, v34, v35
    v_cvt_pk_bf16_f32 v34, v36, v37
    v_cvt_pk_bf16_f32 v35, v38, v39
    v_mfma_f32_32x32x16_bf16 v[168:183], v[20:23], v[156:159], v[168:183]
    v_cvt_pk_bf16_f32 v36, v40, v41
    v_cvt_pk_bf16_f32 v37, v42, v43
    v_cvt_pk_bf16_f32 v38, v44, v45
    v_cvt_pk_bf16_f32 v39, v46, v47
    s_nop 1
    v_mfma_f32_32x32x16_bf16 v[184:199], v[32:35], v[132:135], v[184:199]
    v_cvt_pk_bf16_f32 v48, v48, v49
    v_cvt_pk_bf16_f32 v49, v50, v51
    v_cvt_pk_bf16_f32 v50, v52, v53
    v_cvt_pk_bf16_f32 v51, v54, v55
    v_mfma_f32_32x32x16_bf16 v[184:199], v[36:39], v[156:159], v[184:199]
    v_cvt_pk_bf16_f32 v52, v56, v57
    v_cvt_pk_bf16_f32 v53, v58, v59
    v_cvt_pk_bf16_f32 v54, v60, v61
    v_cvt_pk_bf16_f32 v55, v62, v63
    s_nop 1
    v_mfma_f32_32x32x16_bf16 v[200:215], v[48:51], v[132:135], v[200:215]
    v_cvt_pk_bf16_f32 v64, v64, v65
    v_cvt_pk_bf16_f32 v65, v66, v67
    v_cvt_pk_bf16_f32 v66, v68, v69
    v_cvt_pk_bf16_f32 v67, v70, v71
    v_mfma_f32_32x32x16_bf16 v[200:215], v[52:55], v[156:159], v[200:215]
    v_cvt_pk_bf16_f32 v68, v72, v73
    v_cvt_pk_bf16_f32 v69, v74, v75
    v_cvt_pk_bf16_f32 v70, v76, v77
    v_cvt_pk_bf16_f32 v71, v78, v79
    s_nop 1
    v_mfma_f32_32x32x16_bf16 v[216:231], v[64:67], v[132:135], v[216:231]
    v_cvt_pk_bf16_f32 v80, v80, v81
    v_cvt_pk_bf16_f32 v81, v82, v83
    v_cvt_pk_bf16_f32 v82, v84, v85
    v_cvt_pk_bf16_f32 v83, v86, v87
    v_mfma_f32_32x32x16_bf16 v[216:231], v[68:71], v[156:159], v[216:231]
    v_cvt_pk_bf16_f32 v84, v88, v89
    v_cvt_pk_bf16_f32 v85, v90, v91
    v_cvt_pk_bf16_f32 v86, v92, v93
    v_cvt_pk_bf16_f32 v87, v94, v95
    s_nop 1
    v_mfma_f32_32x32x16_bf16 v[232:247], v[80:83], v[132:135], v[232:247]
    v_mfma_f32_32x32x16_bf16 v[232:247], v[84:87], v[156:159], v[232:247]
    s_lshl_b32 s53, s4, 2
    s_add_u32 s53, s53, s6
    s_lshl_b32 s53, s53, 2
    s_add_u32 s53, s53, s42
    s_lshl_b32 s53, s53, 3
    s_lshl_b32 s54, s5, 1
    s_add_u32 s54, s54, s43
    s_nop 7
    s_nop 3
    v_cvt_pk_bf16_f32 v16, v168, v169
    v_cvt_pk_bf16_f32 v17, v170, v171
    v_cvt_pk_bf16_f32 v18, v172, v173
    v_cvt_pk_bf16_f32 v19, v174, v175
    v_cvt_pk_bf16_f32 v20, v184, v185
    v_cvt_pk_bf16_f32 v21, v186, v187
    v_cvt_pk_bf16_f32 v22, v188, v189
    v_cvt_pk_bf16_f32 v23, v190, v191
    v_cvt_pk_bf16_f32 v24, v200, v201
    v_cvt_pk_bf16_f32 v25, v202, v203
    v_cvt_pk_bf16_f32 v26, v204, v205
    v_cvt_pk_bf16_f32 v27, v206, v207
    v_cvt_pk_bf16_f32 v28, v216, v217
    v_cvt_pk_bf16_f32 v29, v218, v219
    v_cvt_pk_bf16_f32 v30, v220, v221
    v_cvt_pk_bf16_f32 v31, v222, v223
    v_cvt_pk_bf16_f32 v32, v232, v233
    v_cvt_pk_bf16_f32 v33, v234, v235
    v_cvt_pk_bf16_f32 v34, v236, v237
    v_cvt_pk_bf16_f32 v35, v238, v239
    v_cvt_pk_bf16_f32 v36, v176, v177
    v_cvt_pk_bf16_f32 v37, v178, v179
    v_cvt_pk_bf16_f32 v38, v180, v181
    v_cvt_pk_bf16_f32 v39, v182, v183
    v_cvt_pk_bf16_f32 v40, v192, v193
    v_cvt_pk_bf16_f32 v41, v194, v195
    v_cvt_pk_bf16_f32 v42, v196, v197
    v_cvt_pk_bf16_f32 v43, v198, v199
    v_cvt_pk_bf16_f32 v44, v208, v209
    v_cvt_pk_bf16_f32 v45, v210, v211
    v_cvt_pk_bf16_f32 v46, v212, v213
    v_cvt_pk_bf16_f32 v47, v214, v215
    v_cvt_pk_bf16_f32 v48, v224, v225
    v_cvt_pk_bf16_f32 v49, v226, v227
    v_cvt_pk_bf16_f32 v50, v228, v229
    v_cvt_pk_bf16_f32 v51, v230, v231
    v_cvt_pk_bf16_f32 v52, v240, v241
    v_cvt_pk_bf16_f32 v53, v242, v243
    v_cvt_pk_bf16_f32 v54, v244, v245
    v_cvt_pk_bf16_f32 v55, v246, v247
    s_lshl_b32 s47, s3, 1
    s_add_u32 s47, s47, 0
    s_add_u32 s47, s47, s53
    s_lshl_b32 s47, s47, 3
    s_add_u32 s47, s47, s54
    s_mul_i32 s47, s47, 5120
    s_add_u32 s47, s47, 0x400000
    buffer_store_dwordx4 v[16:19], v11, s[28:31], s47 offen offset:0 sc1
    buffer_store_dwordx4 v[20:23], v11, s[28:31], s47 offen offset:1024 sc1
    buffer_store_dwordx4 v[24:27], v11, s[28:31], s47 offen offset:2048 sc1
    buffer_store_dwordx4 v[28:31], v11, s[28:31], s47 offen offset:3072 sc1
    s_add_u32 s47, s47, 4096
    buffer_store_dwordx4 v[32:35], v11, s[28:31], s47 offen offset:0 sc1
    s_lshl_b32 s47, s3, 1
    s_add_u32 s47, s47, 1
    s_add_u32 s47, s47, s53
    s_lshl_b32 s47, s47, 3
    s_add_u32 s47, s47, s54
    s_mul_i32 s47, s47, 5120
    s_add_u32 s47, s47, 0x400000
    buffer_store_dwordx4 v[36:39], v11, s[28:31], s47 offen offset:0 sc1
    buffer_store_dwordx4 v[40:43], v11, s[28:31], s47 offen offset:1024 sc1
    buffer_store_dwordx4 v[44:47], v11, s[28:31], s47 offen offset:2048 sc1
    buffer_store_dwordx4 v[48:51], v11, s[28:31], s47 offen offset:3072 sc1
    s_add_u32 s47, s47, 4096
    buffer_store_dwordx4 v[52:55], v11, s[28:31], s47 offen offset:0 sc1
    s_waitcnt vmcnt(0)
    s_lshl_b32 s47, s2, 2
    s_add_u32 s47, s47, s3
    s_lshl_b32 s47, s47, 6
    s_add_u32 s47, s47, 0x320000
    v_mov_b32 v248, 0
    v_mov_b32 v249, s62
    s_mov_b64 exec, 1
    buffer_store_dword v249, v248, s[28:31], s47 offen sc1
    s_mov_b64 exec, -1
    v_bfe_u32 v248, v0, 1, 2
    v_and_b32 v249, 1, v0
    v_lshl_add_u32 v248, v249, 7, v248
    s_lshl_b32 s47, s4, 2
    s_lshl_b32 s48, s6, 3
    s_add_u32 s47, s47, s48
    s_lshl_b32 s48, s42, 5
    s_add_u32 s47, s47, s48
    v_add_u32 v248, s47, v248
    v_lshlrev_b32 v248, 8, v248
    s_lshr_b32 s48, s54, 1
    s_lshl_b32 s48, s48, 6
    s_add_u32 s47, s48, 0x320000
pollr_100003:
    buffer_load_dword v250, v248, s[28:31], s47 offen sc1
    s_waitcnt vmcnt(0)
    v_cmp_ne_u32 vcc, s62, v250
    s_add_u32 s63, s63, 64
    s_cmp_gt_u32 s63, 600000
    s_cbranch_scc1 pollr_100003_done
    s_nop 2
    s_cbranch_vccnz pollr_100003
pollr_100003_done:
    s_add_u32 s47, s53, s54
    s_mul_i32 s47, s47, 40960
    s_add_u32 s47, s47, 0x400000
    s_lshl_b32 s48, s3, 10
    s_add_u32 s48, s48, s47
    s_add_u32 s49, s47, 4096
    buffer_load_dwordx4 v[16:19], v11, s[28:31], s48 offen sc1
    s_add_u32 s48, s48, 5120
    buffer_load_dwordx4 v[20:23], v11, s[28:31], s48 offen sc1
    s_add_u32 s48, s48, 5120
    buffer_load_dwordx4 v[24:27], v11, s[28:31], s48 offen sc1
    s_add_u32 s48, s48, 5120
    buffer_load_dwordx4 v[28:31], v11, s[28:31], s48 offen sc1
    s_add_u32 s48, s48, 5120
    buffer_load_dwordx4 v[32:35], v11, s[28:31], s48 offen sc1
    s_add_u32 s48, s48, 5120
    buffer_load_dwordx4 v[36:39], v11, s[28:31], s48 offen sc1
    s_add_u32 s48, s48, 5120
    buffer_load_dwordx4 v[40:43], v11, s[28:31], s48 offen sc1
    s_add_u32 s48, s48, 5120
    buffer_load_dwordx4 v[44:47], v11, s[28:31], s48 offen sc1
    s_add_u32 s48, s48, 5120
    s_lshl_b32 s55, s3, 3
    s_lshl_b32 s56, 0xff, s55
    s_mov_b32 s57, s56
    s_mov_b64 exec, s[56:57]
    buffer_load_dwordx4 v[48:51], v11, s[28:31], s49 offen sc1
    s_add_u32 s49, s49, 5120
    buffer_load_dwordx4 v[52:55], v11, s[28:31], s49 offen sc1
    s_add_u32 s49, s49, 5120
    buffer_load_dwordx4 v[56:59], v11, s[28:31], s49 offen sc1
    s_add_u32 s49, s49, 5120
    buffer_load_dwordx4 v[60:63], v11, s[28:31], s49 offen sc1
    s_add_u32 s49, s49, 5120
    buffer_load_dwordx4 v[64:67], v11, s[28:31], s49 offen sc1
    s_add_u32 s49, s49, 5120
    buffer_load_dwordx4 v[68:71], v11, s[28:31], s49 offen sc1
    s_add_u32 s49, s49, 5120
    buffer_load_dwordx4 v[72:75], v11, s[28:31], s49 offen sc1
    s_add_u32 s49, s49, 5120
    buffer_load_dwordx4 v[76:79], v11, s[28:31], s49 offen sc1
    s_add_u32 s49, s49, 5120
    s_mov_b64 exec, -1
    s_lshl_b32 s47, s6, 2
    s_lshr_b32 s48, s54, 1
    s_add_u32 s47, s47, s48
    s_mul_i32 s47, s47, 81920
    s_mul_i32 s48, s4, 1280
    s_add_u32 s47, s47, s48
    s_mul_i32 s48, s42, 320
    s_add_u32 s47, s47, s48
    s_and_b32 s48, s54, 1
    s_lshl_b32 s48, s48, 5
    s_add_u32 s47, s47, s48
    v_and_b32 v248, 31, v0
    v_mul_u32_u24 v248, 2560, v248
    v_lshrrev_b32 v249, 5, v0
    v_lshl_add_u32 v248, v249, 4, v248
    s_lshl_b32 s48, s3, 6
    s_add_u32 s48, s48, s47
    s_add_u32 s49, s47, 256
    s_waitcnt vmcnt(15)
    v_lshlrev_b32 v80, 16, v16
    v_and_b32 v81, 0xffff0000, v16
    v_lshlrev_b32 v82, 16, v17
    v_and_b32 v83, 0xffff0000, v17
    v_lshlrev_b32 v84, 16, v18
    v_and_b32 v85, 0xffff0000, v18
    v_lshlrev_b32 v86, 16, v19
    v_and_b32 v87, 0xffff0000, v19
    s_waitcnt vmcnt(14)
    v_lshlrev_b32 v250, 16, v20
    v_and_b32 v251, 0xffff0000, v20
    v_add_f32 v80, v80, v250
    v_add_f32 v81, v81, v251
    v_lshlrev_b32 v250, 16, v21
    v_and_b32 v251, 0xffff0000, v21
    v_add_f32 v82, v82, v250
    v_add_f32 v83, v83, v251
    v_lshlrev_b32 v250, 16, v22
    v_and_b32 v251, 0xffff0000, v22
    v_add_f32 v84, v84, v250
    v_add_f32 v85, v85, v251
    v_lshlrev_b32 v250, 16, v23
    v_and_b32 v251, 0xffff0000, v23
    v_add_f32 v86, v86, v250
    v_add_f32 v87, v87, v251
    s_waitcnt vmcnt(13)
    v_lshlrev_b32 v250, 16, v24
    v_and_b32 v251, 0xffff0000, v24
    v_add_f32 v80, v80, v250
    v_add_f32 v81, v81, v251
    v_lshlrev_b32 v250, 16, v25
    v_and_b32 v251, 0xffff0000, v25
    v_add_f32 v82, v82, v250
    v_add_f32 v83, v83, v251
    v_lshlrev_b32 v250, 16, v26
    v_and_b32 v251, 0xffff0000, v26
    v_add_f32 v84, v84, v250
    v_add_f32 v85, v85, v251
    v_lshlrev_b32 v250, 16, v27
    v_and_b32 v251, 0xffff0000, v27
    v_add_f32 v86, v86, v250
    v_add_f32 v87, v87, v251
    s_waitcnt vmcnt(12)
    v_lshlrev_b32 v250, 16, v28
    v_and_b32 v251, 0xffff0000, v28
    v_add_f32 v80, v80, v250
    v_add_f32 v81, v81, v251
    v_lshlrev_b32 v250, 16, v29
    v_and_b32 v251, 0xffff0000, v29
    v_add_f32 v82, v82, v250
    v_add_f32 v83, v83, v251
    v_lshlrev_b32 v250, 16, v30
    v_and_b32 v251, 0xffff0000, v30
    v_add_f32 v84, v84, v250
    v_add_f32 v85, v85, v251
    v_lshlrev_b32 v250, 16, v31
    v_and_b32 v251, 0xffff0000, v31
    v_add_f32 v86, v86, v250
    v_add_f32 v87, v87, v251
    s_waitcnt vmcnt(11)
    v_lshlrev_b32 v250, 16, v32
    v_and_b32 v251, 0xffff0000, v32
    v_add_f32 v80, v80, v250
    v_add_f32 v81, v81, v251
    v_lshlrev_b32 v250, 16, v33
    v_and_b32 v251, 0xffff0000, v33
    v_add_f32 v82, v82, v250
    v_add_f32 v83, v83, v251
    v_lshlrev_b32 v250, 16, v34
    v_and_b32 v251, 0xffff0000, v34
    v_add_f32 v84, v84, v250
    v_add_f32 v85, v85, v251
    v_lshlrev_b32 v250, 16, v35
    v_and_b32 v251, 0xffff0000, v35
    v_add_f32 v86, v86, v250
    v_add_f32 v87, v87, v251
    s_waitcnt vmcnt(10)
    v_lshlrev_b32 v250, 16, v36
    v_and_b32 v251, 0xffff0000, v36
    v_add_f32 v80, v80, v250
    v_add_f32 v81, v81, v251
    v_lshlrev_b32 v250, 16, v37
    v_and_b32 v251, 0xffff0000, v37
    v_add_f32 v82, v82, v250
    v_add_f32 v83, v83, v251
    v_lshlrev_b32 v250, 16, v38
    v_and_b32 v251, 0xffff0000, v38
    v_add_f32 v84, v84, v250
    v_add_f32 v85, v85, v251
    v_lshlrev_b32 v250, 16, v39
    v_and_b32 v251, 0xffff0000, v39
    v_add_f32 v86, v86, v250
    v_add_f32 v87, v87, v251
    s_waitcnt vmcnt(9)
    v_lshlrev_b32 v250, 16, v40
    v_and_b32 v251, 0xffff0000, v40
    v_add_f32 v80, v80, v250
    v_add_f32 v81, v81, v251
    v_lshlrev_b32 v250, 16, v41
    v_and_b32 v251, 0xffff0000, v41
    v_add_f32 v82, v82, v250
    v_add_f32 v83, v83, v251
    v_lshlrev_b32 v250, 16, v42
    v_and_b32 v251, 0xffff0000, v42
    v_add_f32 v84, v84, v250
    v_add_f32 v85, v85, v251
    v_lshlrev_b32 v250, 16, v43
    v_and_b32 v251, 0xffff0000, v43
    v_add_f32 v86, v86, v250
    v_add_f32 v87, v87, v251
    s_waitcnt vmcnt(8)
    v_lshlrev_b32 v250, 16, v44
    v_and_b32 v251, 0xffff0000, v44
    v_add_f32 v80, v80, v250
    v_add_f32 v81, v81, v251
    v_lshlrev_b32 v250, 16, v45
    v_and_b32 v251, 0xffff0000, v45
    v_add_f32 v82, v82, v250
    v_add_f32 v83, v83, v251
    v_lshlrev_b32 v250, 16, v46
    v_and_b32 v251, 0xffff0000, v46
    v_add_f32 v84, v84, v250
    v_add_f32 v85, v85, v251
    v_lshlrev_b32 v250, 16, v47
    v_and_b32 v251, 0xffff0000, v47
    v_add_f32 v86, v86, v250
    v_add_f32 v87, v87, v251
    v_cvt_pk_bf16_f32 v80, v80, v81
    v_cvt_pk_bf16_f32 v81, v82, v83
    v_cvt_pk_bf16_f32 v82, v84, v85
    v_cvt_pk_bf16_f32 v83, v86, v87
    s_mov_b64 exec, -1
    s_nop 1
    v_permlane32_swap_b32 v80, v82
    v_permlane32_swap_b32 v81, v83
    buffer_store_dwordx4 v[80:83], v248, s[32:35], s48 offen
    s_mov_b64 exec, s[56:57]
    s_waitcnt vmcnt(8)
    v_lshlrev_b32 v88, 16, v48
    v_and_b32 v89, 0xffff0000, v48
    v_lshlrev_b32 v90, 16, v49
    v_and_b32 v91, 0xffff0000, v49
    v_lshlrev_b32 v92, 16, v50
    v_and_b32 v93, 0xffff0000, v50
    v_lshlrev_b32 v94, 16, v51
    v_and_b32 v95, 0xffff0000, v51
    s_waitcnt vmcnt(7)
    v_lshlrev_b32 v250, 16, v52
    v_and_b32 v251, 0xffff0000, v52
    v_add_f32 v88, v88, v250
    v_add_f32 v89, v89, v251
    v_lshlrev_b32 v250, 16, v53
    v_and_b32 v251, 0xffff0000, v53
    v_add_f32 v90, v90, v250
    v_add_f32 v91, v91, v251
    v_lshlrev_b32 v250, 16, v54
    v_and_b32 v251, 0xffff0000, v54
    v_add_f32 v92, v92, v250
    v_add_f32 v93, v93, v251
    v_lshlrev_b32 v250, 16, v55
    v_and_b32 v251, 0xffff0000, v55
    v_add_f32 v94, v94, v250
    v_add_f32 v95, v95, v251
    s_waitcnt vmcnt(6)
    v_lshlrev_b32 v250, 16, v56
    v_and_b32 v251, 0xffff0000, v56
    v_add_f32 v88, v88, v250
    v_add_f32 v89, v89, v251
    v_lshlrev_b32 v250, 16, v57
    v_and_b32 v251, 0xffff0000, v57
    v_add_f32 v90, v90, v250
    v_add_f32 v91, v91, v251
    v_lshlrev_b32 v250, 16, v58
    v_and_b32 v251, 0xffff0000, v58
    v_add_f32 v92, v92, v250
    v_add_f32 v93, v93, v251
    v_lshlrev_b32 v250, 16, v59
    v_and_b32 v251, 0xffff0000, v59
    v_add_f32 v94, v94, v250
    v_add_f32 v95, v95, v251
    s_waitcnt vmcnt(5)
    v_lshlrev_b32 v250, 16, v60
    v_and_b32 v251, 0xffff0000, v60
    v_add_f32 v88, v88, v250
    v_add_f32 v89, v89, v251
    v_lshlrev_b32 v250, 16, v61
    v_and_b32 v251, 0xffff0000, v61
    v_add_f32 v90, v90, v250
    v_add_f32 v91, v91, v251
    v_lshlrev_b32 v250, 16, v62
    v_and_b32 v251, 0xffff0000, v62
    v_add_f32 v92, v92, v250
    v_add_f32 v93, v93, v251
    v_lshlrev_b32 v250, 16, v63
    v_and_b32 v251, 0xffff0000, v63
    v_add_f32 v94, v94, v250
    v_add_f32 v95, v95, v251
    s_waitcnt vmcnt(4)
    v_lshlrev_b32 v250, 16, v64
    v_and_b32 v251, 0xffff0000, v64
    v_add_f32 v88, v88, v250
    v_add_f32 v89, v89, v251
    v_lshlrev_b32 v250, 16, v65
    v_and_b32 v251, 0xffff0000, v65
    v_add_f32 v90, v90, v250
    v_add_f32 v91, v91, v251
    v_lshlrev_b32 v250, 16, v66
    v_and_b32 v251, 0xffff0000, v66
    v_add_f32 v92, v92, v250
    v_add_f32 v93, v93, v251
    v_lshlrev_b32 v250, 16, v67
    v_and_b32 v251, 0xffff0000, v67
    v_add_f32 v94, v94, v250
    v_add_f32 v95, v95, v251
    s_waitcnt vmcnt(3)
    v_lshlrev_b32 v250, 16, v68
    v_and_b32 v251, 0xffff0000, v68
    v_add_f32 v88, v88, v250
    v_add_f32 v89, v89, v251
    v_lshlrev_b32 v250, 16, v69
    v_and_b32 v251, 0xffff0000, v69
    v_add_f32 v90, v90, v250
    v_add_f32 v91, v91, v251
    v_lshlrev_b32 v250, 16, v70
    v_and_b32 v251, 0xffff0000, v70
    v_add_f32 v92, v92, v250
    v_add_f32 v93, v93, v251
    v_lshlrev_b32 v250, 16, v71
    v_and_b32 v251, 0xffff0000, v71
    v_add_f32 v94, v94, v250
    v_add_f32 v95, v95, v251
    s_waitcnt vmcnt(2)
    v_lshlrev_b32 v250, 16, v72
    v_and_b32 v251, 0xffff0000, v72
    v_add_f32 v88, v88, v250
    v_add_f32 v89, v89, v251
    v_lshlrev_b32 v250, 16, v73
    v_and_b32 v251, 0xffff0000, v73
    v_add_f32 v90, v90, v250
    v_add_f32 v91, v91, v251
    v_lshlrev_b32 v250, 16, v74
    v_and_b32 v251, 0xffff0000, v74
    v_add_f32 v92, v92, v250
    v_add_f32 v93, v93, v251
    v_lshlrev_b32 v250, 16, v75
    v_and_b32 v251, 0xffff0000, v75
    v_add_f32 v94, v94, v250
    v_add_f32 v95, v95, v251
    s_waitcnt vmcnt(1)
    v_lshlrev_b32 v250, 16, v76
    v_and_b32 v251, 0xffff0000, v76
    v_add_f32 v88, v88, v250
    v_add_f32 v89, v89, v251
    v_lshlrev_b32 v250, 16, v77
    v_and_b32 v251, 0xffff0000, v77
    v_add_f32 v90, v90, v250
    v_add_f32 v91, v91, v251
    v_lshlrev_b32 v250, 16, v78
    v_and_b32 v251, 0xffff0000, v78
    v_add_f32 v92, v92, v250
    v_add_f32 v93, v93, v251
    v_lshlrev_b32 v250, 16, v79
    v_and_b32 v251, 0xffff0000, v79
    v_add_f32 v94, v94, v250
    v_add_f32 v95, v95, v251
    v_cvt_pk_bf16_f32 v88, v88, v89
    v_cvt_pk_bf16_f32 v89, v90, v91
    v_cvt_pk_bf16_f32 v90, v92, v93
    v_cvt_pk_bf16_f32 v91, v94, v95
    s_mov_b64 exec, -1
    s_nop 1
    v_permlane32_swap_b32 v88, v90
    v_permlane32_swap_b32 v89, v91
    s_mov_b64 exec, s[56:57]
    buffer_store_dwordx4 v[88:91], v248, s[32:35], s49 offen
    s_mov_b64 exec, -1
    s_endpgm
common_slow:
common_slow2:
    ds_read_b32 v12, v10
    s_waitcnt lgkmcnt(0)
    v_cmp_gt_u32 vcc, s61, v12
    s_add_u32 s63, s63, 1
    s_cmp_gt_u32 s63, 300000
    s_cbranch_scc1 common_ret
    s_nop 1
    s_cbranch_vccnz common_slow2
common_ret:
    s_add_u32 s56, s56, 4
    s_addc_u32 s57, s57, 0
    s_setpc_b64 s[56:57]
nonce_100001:
    buffer_load_dword v249, v248, s[36:39], 0 offen sc1
    s_waitcnt vmcnt(0)
    v_readfirstlane_b32 s62, v249
    s_add_u32 s63, s63, 64
    s_cmp_gt_u32 s63, 300000
    s_cbranch_scc1 nonce_100001_ok
    s_cmp_lg_u32 s62, 0
    s_cbranch_scc0 nonce_100001
    s_branch nonce_100001_ok
kend:
    s_endpgm
.p2align 8
seqtab:
    .long 1
    .long 2
    .long 3
    .long 4
    .long 5
    .long 6
    .long 7
    .long 8
    .long 9
    .long 10
    .long 11
    .long 12
    .long 13
    .long 14
    .long 15
    .long 16
    .long 17
    .long 18
    .long 19
    .long 20
    .long 21
    .long 22
    .long 23
    .long 24
    .long 25
    .long 26
    .long 27
    .long 28
    .long 29
    .long 30
    .long 31
    .long 32
    .long 33
    .long 34
    .long 35
    .long 36
    .long 37
    .long 38
    .long 39
    .long 40
    .long 41
    .long 42
    .long 43
    .long 44
    .long 45
    .long 46
    .long 47
    .long 48
    .long 49
    .long 50
    .long 51
    .long 52
    .long 53
    .long 54
    .long 55
    .long 56
    .long 57
    .long 58
    .long 59
    .long 60
    .long 61
    .long 62
    .long 63
    .long 64
    .long 65
    .long 66
    .long 67
    .long 68
    .long 69
    .long 70
    .long 71
    .long 72
    .long 73
    .long 74
    .long 75
    .long 76
    .long 77
    .long 78
    .long 79
    .long 80
    .long 81
    .long 82
    .long 83
    .long 84
    .long 85
    .long 86
    .long 87
    .long 88
    .long 89
    .long 90
    .long 91
    .long 92
    .long 93
    .long 94
    .long 95
    .long 96
    .long 97
    .long 98
    .long 99
    .long 100
    .long 101
    .long 102
    .long 103
    .long 104
    .long 105
    .long 106
    .long 107
    .long 108
    .long 109
    .long 110
    .long 111
    .long 112
    .long 113
    .long 114
    .long 115
    .long 116
    .long 117
    .long 118
    .long 119
    .long 120
    .long 121
    .long 122
    .long 123
    .long 124
    .long 125
    .long 126
    .long 127
    .long 128
.section .rodata,"a"
.p2align 6
.amdhsa_kernel concat_heads__gqa_block_cached__mha_block_cached__near_ridge_kernel
  .amdhsa_next_free_vgpr 256
  .amdhsa_next_free_sgpr 102
  .amdhsa_accum_offset 256
  .amdhsa_group_segment_fixed_size 0
  .amdhsa_kernarg_size 104
  .amdhsa_user_sgpr_count 2
  .amdhsa_user_sgpr_kernarg_segment_ptr 1
  .amdhsa_system_sgpr_workgroup_id_x 1
.end_amdhsa_kernel
```
